```python
import torch

def _softmax(x, axis=-1):
    return torch.softmax(x, dim=axis)
def _gelu(x):
    return torch.nn.functional.gelu(x, approximate="tanh")
def _silu(x):
    return torch.nn.functional.silu(x)
def _sigmoid(x):
    return torch.sigmoid(x)
def _layernorm(x, axis=-1, eps=1e-5):
    m = x.mean(dim=axis, keepdim=True)
    v = x.var(dim=axis, keepdim=True, unbiased=False)
    return (x - m) / torch.sqrt(v + eps)
def _scatter_add(tgt, idx, src, axis=0):
    return tgt.clone().index_add_(axis, idx, src)
def _segment_sum(src, seg, n):
    out = torch.zeros((n,) + src.shape[1:], dtype=src.dtype)
    return out.index_add_(0, seg, src)
def _pad(x, pw):
    flat = tuple(v for pair in reversed(pw) for v in pair)
    return torch.nn.functional.pad(x, flat)

kernel_name = 'concat_heads__ssm_conv_h3__linear_attn_block__prompt'

def setup_inputs():

    _w = (lambda a: (lambda t: t.to(torch.bfloat16) if t.is_floating_point() else t)(torch.as_tensor(a)))
    def _A_setup():
        B, S, D = 1, 2048, 640
        ks = 4
        return {
            "q": _w((lambda *s: torch.randn(*s, dtype=torch.bfloat16) * 0.05)(B, S, D)),
            "k": _w((lambda *s: torch.randn(*s, dtype=torch.bfloat16) * 0.4)(B, S, D)),
            "v": _w((lambda *s: torch.randn(*s, dtype=torch.bfloat16) * 0.4)(B, S, D)),
            "shift_k": _w((lambda *s: torch.randn(*s, dtype=torch.bfloat16) * 0.4)(D, ks) * 0.5),
            "ssm_k": _w((lambda *s: torch.randn(*s, dtype=torch.bfloat16) * 0.4)(D, S) * (1.0 / S ** 0.5)),
            "ssm_D": _w((lambda *s: torch.randn(*s, dtype=torch.bfloat16) * 0.4)(D)),
        }
    _A_in = _A_setup()

    def _B_setup():
        B, S, D = 1, 2048, 640
        return {
            "x": _w((lambda *s: torch.randn(*s, dtype=torch.bfloat16) * 0.05)(B, S, D)),
            "wqkv": _w((lambda *s: torch.randn(*s, dtype=torch.bfloat16) * 0.8)(D, 3 * D)),
            "wo": _w((lambda *s: torch.randn(*s, dtype=torch.bfloat16) * 0.05)(D, D)),
        }
    _B_in = _B_setup()

    return {
        "A_q": _A_in["q"],
        "A_k": _A_in["k"],
        "A_v": _A_in["v"],
        "A_shift_k": _A_in["shift_k"],
        "A_ssm_k": _A_in["ssm_k"],
        "A_ssm_D": _A_in["ssm_D"],
        "B_x": _B_in["x"],
        "B_wqkv": _B_in["wqkv"],
        "B_wo": _B_in["wo"],
    }

def reference(A_q, A_k, A_v, A_shift_k, A_ssm_k, A_ssm_D, B_x, B_wqkv, B_wo):
    def _A_ref(q, k, v, shift_k, ssm_k, ssm_D):
        B, S, D = q.shape
        ks = shift_k.shape[-1]
        k_pad = _pad(k, ((0, 0), (ks - 1, 0), (0, 0)))
        k_shift = torch.zeros_like(k)
        for t in range(ks):
            k_shift = k_shift + k_pad[:, t:t + S, :] * shift_k[:, ks - 1 - t][None, None, :]
        kv = k_shift * v
        L = 2 * S
        kv_pad = _pad(kv, ((0, 0), (0, S), (0, 0)))
        kf_pad = _pad(ssm_k, ((0, 0), (0, S)))
        kv_f = (lambda x, axes=(-2,-1): torch.fft.rfft2(x.float(), dim=axes))(kv_pad[:, None, :, :], axes=(1, 2))
        kf_f = (lambda x, axes=(-2,-1): torch.fft.rfft2(x.float(), dim=axes))(kf_pad[:, None, :], axes=(1, 2))
        kf_f = (lambda x, *d: x.permute(*d))(kf_f, 1, 2, 0)
        y_f = kv_f * kf_f[None, :, :, :]
        y = (lambda x, s, axes=(-2,-1): torch.fft.irfft2(x, s=s, dim=axes).to(torch.bfloat16))(y_f, (1, L), axes=(1, 2))[:, 0, :S, :]
        y = y + kv * ssm_D[None, None, :]
        return q * y

    def _B_ref(x, wqkv, wo):
        B, S, D = x.shape
        H = 32; Dh = D // H
        qkv = (lambda x, *d: x.permute(*d))((x @ wqkv).reshape(B, S, 3, H, Dh), 2, 0, 3, 1, 4)
        q, k, v = qkv[0], qkv[1], qkv[2]
        phi = lambda t: torch.where(t > 0, t + 1, torch.exp(t)) + 1e-6
        pq, pk = phi(q), phi(k)
        kv = torch.einsum("bhsd,bhse->bhde", pk, v)
        z = torch.einsum("bhsd->bhd", pk)
        num = torch.einsum("bhqd,bhde->bhqe", pq, kv)
        den = torch.einsum("bhqd,bhd->bhq", pq, z)[..., None] + 1e-6
        o = num / den
        return (lambda x, *d: x.permute(*d))(o, 0, 2, 1, 3).reshape(B, S, D) @ wo

    a = _A_ref(A_q, A_k, A_v, A_shift_k, A_ssm_k, A_ssm_D)
    b = _B_ref(B_x, B_wqkv, B_wo)
    return torch.concatenate([a, b], axis=-1)
```

```asm
; @launch grid=(256,1,1) block=(512,1,1) lds=161280
.amdgcn_target "amdgcn-amd-amdhsa--gfx950"
.text
.globl concat_heads__ssm_conv_h3__linear_attn_block__prompt_kernel
.p2align 8
.type concat_heads__ssm_conv_h3__linear_attn_block__prompt_kernel,@function
concat_heads__ssm_conv_h3__linear_attn_block__prompt_kernel:
    s_and_b32 s3, s2, 0xf0
    s_cmp_lg_u32 s3, 0x80
    s_cbranch_scc1 L_NOPF
    s_getpc_b64 s[4:5]
    v_lshlrev_b32 v2, 7, v0
    v_min_u32 v2, L_END-concat_heads__ssm_conv_h3__linear_attn_block__prompt_kernel-128, v2
    global_load_dword v252, v2, s[4:5]
L_NOPF:
    s_cmp_ge_u32 s2, 256
    s_cbranch_scc1 L_END
    s_load_dwordx16 s[8:23], s[0:1], 0
    s_load_dwordx8 s[24:31], s[0:1], 64
    v_lshrrev_b32 v2, 6, v0
    v_and_b32 v1, 63, v0
    v_readfirstlane_b32 s3, v2
    s_and_b32 s58, s2, 7
    s_lshr_b32 s59, s2, 3
    s_lshr_b32 s6, s58, 1
    s_lshl_b32 s6, s6, 2
    s_and_b32 s7, s59, 3
    s_add_u32 s52, s6, s7
    s_and_b32 s4, s58, 1
    s_mul_i32 s54, s4, 5
    s_cmp_ge_u32 s59, 16
    s_cbranch_scc1 L_A
    s_lshr_b32 s6, s59, 2
    s_add_u32 s54, s54, s6
    s_lshl_b32 s4, s4, 2
    s_add_u32 s53, s4, s6
    s_cmp_lt_u32 s3, 4
    s_cbranch_scc1 L_BC
    s_setprio 3
    v_lshrrev_b32 v2, 3, v1
    v_lshrrev_b32 v3, 4, v1
    v_and_b32 v4, 7, v1
    v_mul_u32_u24 v2, 1280, v2
    v_xor_b32 v3, v3, v4
    s_sub_u32 s60, s3, 4
    s_lshl_b32 s67, s52, 2
    s_add_u32 s67, s67, s60
    s_mul_i32 s61, s67, 40960
    s_lshl_b32 s63, s60, 12
    v_lshl_add_u32 v6, v3, 4, v2
    v_xor_b32 v7, 64, v6
    v_add_u32 v8, 18432, v6
    v_add_u32 v9, 27648, v7
    v_add_u32 v7, 9216, v7
    s_movk_i32 s4, 1200
    s_movk_i32 s5, -80
    s_movk_i32 s69, 3840
    s_mul_i32 s62, s53, 160
    s_add_u32 s62, s62, 1280
    s_mul_i32 s67, s60, 61440
    s_add_u32 s62, s62, s67
    s_mul_i32 s64, s60, 5120
    s_add_u32 s64, s64, 49152
    s_mul_i32 s65, s60, 2688
    s_add_u32 s65, s65, 110592
    s_add_u32 s67, s52, s53
    s_and_b32 s67, s67, 1
    s_cbranch_scc1 ordB_1
    v_add_u32 v2, 0, v1
    v_cmp_le_u32 vcc, 88, v2
    v_subrev_u32 v3, 88, v2
    v_min_u32 v2, 79, v2
    v_min_u32 v3, 79, v3
    v_cndmask_b32 v2, v2, v3, vcc
    v_cndmask_b32 v4, 0, 8, vcc
    v_mul_u32_u24 v3, 205, v2
    v_lshrrev_b32 v3, 11, v3
    v_add_u32 v4, v4, v3
    v_mul_u32_u24 v3, 10, v3
    v_sub_u32 v2, v2, v3
    v_lshlrev_b32 v2, 4, v2
    v_mad_u32_u24 v2, v4, s69, v2
    v_subrev_u32 v15, 0, v2
    s_waitcnt lgkmcnt(0)
    s_mov_b32 s32, s20
    s_mov_b32 s33, s21
    s_mov_b32 s34, 2621440
    s_mov_b32 s35, 0x20000
    s_mov_b32 s36, s22
    s_mov_b32 s37, s23
    s_mov_b32 s38, 2457600
    s_mov_b32 s39, 0x20000
    s_add_u32 m0, s63, 16384
    s_nop 0
    buffer_load_dwordx4 v6, s[32:35], s61 offen offset:0 lds
    buffer_load_dwordx4 v7, s[32:35], s61 offen offset:1024 lds
    buffer_load_dwordx4 v8, s[32:35], s61 offen offset:2048 lds
    buffer_load_dwordx4 v9, s[32:35], s61 offen offset:3072 lds
    s_add_u32 m0, s65, 21504
    s_sub_u32 s66, s62, 1280
    buffer_load_dwordx4 v15, s[36:39], s66 offen offset:0 lds
    v_add_u32 v2, 64, v1
    v_cmp_le_u32 vcc, 88, v2
    v_subrev_u32 v3, 88, v2
    v_min_u32 v2, 79, v2
    v_min_u32 v3, 79, v3
    v_cndmask_b32 v2, v2, v3, vcc
    v_cndmask_b32 v4, 0, 8, vcc
    v_mul_u32_u24 v3, 205, v2
    v_lshrrev_b32 v3, 11, v3
    v_add_u32 v4, v4, v3
    v_mul_u32_u24 v3, 10, v3
    v_sub_u32 v2, v2, v3
    v_lshlrev_b32 v2, 4, v2
    v_mad_u32_u24 v2, v4, s69, v2
    v_subrev_u32 v16, 1024, v2
    buffer_load_dwordx4 v16, s[36:39], s66 offen offset:1024 lds
    v_add_u32 v2, 128, v1
    v_cmp_le_u32 vcc, 88, v2
    v_subrev_u32 v3, 88, v2
    v_min_u32 v2, 79, v2
    v_min_u32 v3, 79, v3
    v_cndmask_b32 v2, v2, v3, vcc
    v_cndmask_b32 v4, 0, 8, vcc
    v_mul_u32_u24 v3, 205, v2
    v_lshrrev_b32 v3, 11, v3
    v_add_u32 v4, v4, v3
    v_mul_u32_u24 v3, 10, v3
    v_sub_u32 v2, v2, v3
    v_lshlrev_b32 v2, 4, v2
    v_mad_u32_u24 v2, v4, s69, v2
    v_subrev_u32 v17, 2048, v2
    s_mov_b32 exec_hi, 0xff
    buffer_load_dwordx4 v17, s[36:39], s66 offen offset:2048 lds
    s_mov_b32 exec_hi, -1
    s_add_u32 m0, s64, 0
    s_nop 0
    v_mul_u32_u24 v3, 3277, v1
    v_lshrrev_b32 v3, 16, v3
    v_mul_u32_u24 v4, 20, v3
    v_sub_u32 v2, v1, v4
    v_mul_u32_u24 v4, 52, v2
    v_lshlrev_b32 v2, 4, v2
    v_mad_u32_u24 v2, v3, s69, v2
    v_bfe_u32 v5, v4, 8, 1
    v_lshrrev_b32 v4, 9, v4
    v_mad_u32_u24 v2, v5, s4, v2
    v_mad_i32_i24 v10, v4, s5, v2
    buffer_load_dwordx4 v10, s[36:39], s62 offen offset:0 lds
    v_add_u32 v2, 64, v1
    v_mul_u32_u24 v3, 3277, v2
    v_lshrrev_b32 v3, 16, v3
    v_mul_u32_u24 v4, 20, v3
    v_sub_u32 v2, v2, v4
    v_mul_u32_u24 v4, 52, v2
    v_lshlrev_b32 v2, 4, v2
    v_mad_u32_u24 v2, v3, s69, v2
    v_bfe_u32 v5, v4, 8, 1
    v_lshrrev_b32 v4, 9, v4
    v_mad_u32_u24 v2, v5, s4, v2
    v_mad_i32_i24 v2, v4, s5, v2
    v_subrev_u32 v11, 1024, v2
    buffer_load_dwordx4 v11, s[36:39], s62 offen offset:1024 lds
    v_add_u32 v2, 128, v1
    v_mul_u32_u24 v3, 3277, v2
    v_lshrrev_b32 v3, 16, v3
    v_mul_u32_u24 v4, 20, v3
    v_sub_u32 v2, v2, v4
    v_lshrrev_b32 v4, 2, v3
    v_and_b32 v4, 2, v4
    v_xor_b32 v2, v2, v4
    v_mul_u32_u24 v4, 52, v2
    v_lshlrev_b32 v2, 4, v2
    v_mad_u32_u24 v2, v3, s69, v2
    v_bfe_u32 v5, v4, 8, 1
    v_lshrrev_b32 v4, 9, v4
    v_mad_u32_u24 v2, v5, s4, v2
    v_mad_i32_i24 v2, v4, s5, v2
    v_subrev_u32 v12, 2048, v2
    buffer_load_dwordx4 v12, s[36:39], s62 offen offset:2048 lds
    v_add_u32 v2, 192, v1
    v_mul_u32_u24 v3, 3277, v2
    v_lshrrev_b32 v3, 16, v3
    v_mul_u32_u24 v4, 20, v3
    v_sub_u32 v2, v2, v4
    v_xor_b32 v2, 2, v2
    v_mul_u32_u24 v4, 52, v2
    v_lshlrev_b32 v2, 4, v2
    v_mad_u32_u24 v2, v3, s69, v2
    v_bfe_u32 v5, v4, 8, 1
    v_lshrrev_b32 v4, 9, v4
    v_mad_u32_u24 v2, v5, s4, v2
    v_mad_i32_i24 v2, v4, s5, v2
    v_subrev_u32 v13, 3072, v2
    buffer_load_dwordx4 v13, s[36:39], s62 offen offset:3072 lds
    v_add_u32 v2, 256, v1
    v_mul_u32_u24 v3, 3277, v2
    v_lshrrev_b32 v3, 16, v3
    v_mul_u32_u24 v4, 20, v3
    v_sub_u32 v2, v2, v4
    v_xor_b32 v2, 2, v2
    v_mul_u32_u24 v4, 52, v2
    v_lshlrev_b32 v2, 4, v2
    v_mad_u32_u24 v2, v3, s69, v2
    v_bfe_u32 v5, v4, 8, 1
    v_lshrrev_b32 v4, 9, v4
    v_mad_u32_u24 v2, v5, s4, v2
    v_mad_i32_i24 v14, v4, s5, v2
    s_add_u32 m0, s64, 4096
    s_nop 0
    buffer_load_dwordx4 v14, s[36:39], s62 offen offset:0 lds
    s_branch ordJ_2
ordB_1:
    v_mul_u32_u24 v3, 3277, v1
    v_lshrrev_b32 v3, 16, v3
    v_mul_u32_u24 v4, 20, v3
    v_sub_u32 v2, v1, v4
    v_mul_u32_u24 v4, 52, v2
    v_lshlrev_b32 v2, 4, v2
    v_mad_u32_u24 v2, v3, s69, v2
    v_bfe_u32 v5, v4, 8, 1
    v_lshrrev_b32 v4, 9, v4
    v_mad_u32_u24 v2, v5, s4, v2
    v_mad_i32_i24 v10, v4, s5, v2
    s_waitcnt lgkmcnt(0)
    s_mov_b32 s32, s20
    s_mov_b32 s33, s21
    s_mov_b32 s34, 2621440
    s_mov_b32 s35, 0x20000
    s_mov_b32 s36, s22
    s_mov_b32 s37, s23
    s_mov_b32 s38, 2457600
    s_mov_b32 s39, 0x20000
    s_add_u32 m0, s64, 0
    s_nop 0
    buffer_load_dwordx4 v10, s[36:39], s62 offen offset:0 lds
    v_add_u32 v2, 64, v1
    v_mul_u32_u24 v3, 3277, v2
    v_lshrrev_b32 v3, 16, v3
    v_mul_u32_u24 v4, 20, v3
    v_sub_u32 v2, v2, v4
    v_mul_u32_u24 v4, 52, v2
    v_lshlrev_b32 v2, 4, v2
    v_mad_u32_u24 v2, v3, s69, v2
    v_bfe_u32 v5, v4, 8, 1
    v_lshrrev_b32 v4, 9, v4
    v_mad_u32_u24 v2, v5, s4, v2
    v_mad_i32_i24 v2, v4, s5, v2
    v_subrev_u32 v11, 1024, v2
    buffer_load_dwordx4 v11, s[36:39], s62 offen offset:1024 lds
    v_add_u32 v2, 128, v1
    v_mul_u32_u24 v3, 3277, v2
    v_lshrrev_b32 v3, 16, v3
    v_mul_u32_u24 v4, 20, v3
    v_sub_u32 v2, v2, v4
    v_lshrrev_b32 v4, 2, v3
    v_and_b32 v4, 2, v4
    v_xor_b32 v2, v2, v4
    v_mul_u32_u24 v4, 52, v2
    v_lshlrev_b32 v2, 4, v2
    v_mad_u32_u24 v2, v3, s69, v2
    v_bfe_u32 v5, v4, 8, 1
    v_lshrrev_b32 v4, 9, v4
    v_mad_u32_u24 v2, v5, s4, v2
    v_mad_i32_i24 v2, v4, s5, v2
    v_subrev_u32 v12, 2048, v2
    buffer_load_dwordx4 v12, s[36:39], s62 offen offset:2048 lds
    v_add_u32 v2, 192, v1
    v_mul_u32_u24 v3, 3277, v2
    v_lshrrev_b32 v3, 16, v3
    v_mul_u32_u24 v4, 20, v3
    v_sub_u32 v2, v2, v4
    v_xor_b32 v2, 2, v2
    v_mul_u32_u24 v4, 52, v2
    v_lshlrev_b32 v2, 4, v2
    v_mad_u32_u24 v2, v3, s69, v2
    v_bfe_u32 v5, v4, 8, 1
    v_lshrrev_b32 v4, 9, v4
    v_mad_u32_u24 v2, v5, s4, v2
    v_mad_i32_i24 v2, v4, s5, v2
    v_subrev_u32 v13, 3072, v2
    buffer_load_dwordx4 v13, s[36:39], s62 offen offset:3072 lds
    v_add_u32 v2, 256, v1
    v_mul_u32_u24 v3, 3277, v2
    v_lshrrev_b32 v3, 16, v3
    v_mul_u32_u24 v4, 20, v3
    v_sub_u32 v2, v2, v4
    v_xor_b32 v2, 2, v2
    v_mul_u32_u24 v4, 52, v2
    v_lshlrev_b32 v2, 4, v2
    v_mad_u32_u24 v2, v3, s69, v2
    v_bfe_u32 v5, v4, 8, 1
    v_lshrrev_b32 v4, 9, v4
    v_mad_u32_u24 v2, v5, s4, v2
    v_mad_i32_i24 v14, v4, s5, v2
    s_add_u32 m0, s64, 4096
    s_nop 0
    buffer_load_dwordx4 v14, s[36:39], s62 offen offset:0 lds
    s_add_u32 m0, s63, 16384
    s_nop 0
    buffer_load_dwordx4 v6, s[32:35], s61 offen offset:0 lds
    buffer_load_dwordx4 v7, s[32:35], s61 offen offset:1024 lds
    buffer_load_dwordx4 v8, s[32:35], s61 offen offset:2048 lds
    buffer_load_dwordx4 v9, s[32:35], s61 offen offset:3072 lds
    s_add_u32 m0, s65, 21504
    s_sub_u32 s66, s62, 1280
    v_add_u32 v2, 0, v1
    v_cmp_le_u32 vcc, 88, v2
    v_subrev_u32 v3, 88, v2
    v_min_u32 v2, 79, v2
    v_min_u32 v3, 79, v3
    v_cndmask_b32 v2, v2, v3, vcc
    v_cndmask_b32 v4, 0, 8, vcc
    v_mul_u32_u24 v3, 205, v2
    v_lshrrev_b32 v3, 11, v3
    v_add_u32 v4, v4, v3
    v_mul_u32_u24 v3, 10, v3
    v_sub_u32 v2, v2, v3
    v_lshlrev_b32 v2, 4, v2
    v_mad_u32_u24 v2, v4, s69, v2
    v_subrev_u32 v15, 0, v2
    buffer_load_dwordx4 v15, s[36:39], s66 offen offset:0 lds
    v_add_u32 v2, 64, v1
    v_cmp_le_u32 vcc, 88, v2
    v_subrev_u32 v3, 88, v2
    v_min_u32 v2, 79, v2
    v_min_u32 v3, 79, v3
    v_cndmask_b32 v2, v2, v3, vcc
    v_cndmask_b32 v4, 0, 8, vcc
    v_mul_u32_u24 v3, 205, v2
    v_lshrrev_b32 v3, 11, v3
    v_add_u32 v4, v4, v3
    v_mul_u32_u24 v3, 10, v3
    v_sub_u32 v2, v2, v3
    v_lshlrev_b32 v2, 4, v2
    v_mad_u32_u24 v2, v4, s69, v2
    v_subrev_u32 v16, 1024, v2
    buffer_load_dwordx4 v16, s[36:39], s66 offen offset:1024 lds
    v_add_u32 v2, 128, v1
    v_cmp_le_u32 vcc, 88, v2
    v_subrev_u32 v3, 88, v2
    v_min_u32 v2, 79, v2
    v_min_u32 v3, 79, v3
    v_cndmask_b32 v2, v2, v3, vcc
    v_cndmask_b32 v4, 0, 8, vcc
    v_mul_u32_u24 v3, 205, v2
    v_lshrrev_b32 v3, 11, v3
    v_add_u32 v4, v4, v3
    v_mul_u32_u24 v3, 10, v3
    v_sub_u32 v2, v2, v3
    v_lshlrev_b32 v2, 4, v2
    v_mad_u32_u24 v2, v4, s69, v2
    v_subrev_u32 v17, 2048, v2
    s_mov_b32 exec_hi, 0xff
    buffer_load_dwordx4 v17, s[36:39], s66 offen offset:2048 lds
    s_mov_b32 exec_hi, -1
ordJ_2:
    s_add_u32 s61, s61, 128
    s_add_u32 s62, s62, 245760
    s_add_u32 m0, s63, 32768
    s_nop 0
    buffer_load_dwordx4 v6, s[32:35], s61 offen offset:0 lds
    buffer_load_dwordx4 v7, s[32:35], s61 offen offset:1024 lds
    buffer_load_dwordx4 v8, s[32:35], s61 offen offset:2048 lds
    buffer_load_dwordx4 v9, s[32:35], s61 offen offset:3072 lds
    s_add_u32 s61, s61, 128
    s_waitcnt vmcnt(4)
    s_barrier
    s_add_u32 m0, s64, 20480
    s_nop 0
    buffer_load_dwordx4 v10, s[36:39], s62 offen offset:0 lds
    buffer_load_dwordx4 v11, s[36:39], s62 offen offset:1024 lds
    buffer_load_dwordx4 v12, s[36:39], s62 offen offset:2048 lds
    buffer_load_dwordx4 v13, s[36:39], s62 offen offset:3072 lds
    s_add_u32 m0, s64, 24576
    s_nop 0
    buffer_load_dwordx4 v14, s[36:39], s62 offen offset:0 lds
    s_add_u32 m0, s65, 0
    s_sub_u32 s66, s62, 1280
    buffer_load_dwordx4 v15, s[36:39], s66 offen offset:0 lds
    buffer_load_dwordx4 v16, s[36:39], s66 offen offset:1024 lds
    s_mov_b32 exec_hi, 0xff
    buffer_load_dwordx4 v17, s[36:39], s66 offen offset:2048 lds
    s_mov_b32 exec_hi, -1
    s_add_u32 s62, s62, 245760
    s_add_u32 m0, s63, 0
    s_nop 0
    buffer_load_dwordx4 v6, s[32:35], s61 offen offset:0 lds
    buffer_load_dwordx4 v7, s[32:35], s61 offen offset:1024 lds
    buffer_load_dwordx4 v8, s[32:35], s61 offen offset:2048 lds
    buffer_load_dwordx4 v9, s[32:35], s61 offen offset:3072 lds
    s_add_u32 s61, s61, 128
    s_waitcnt vmcnt(4)
    s_barrier
    s_add_u32 m0, s64, 40960
    s_nop 0
    buffer_load_dwordx4 v10, s[36:39], s62 offen offset:0 lds
    buffer_load_dwordx4 v11, s[36:39], s62 offen offset:1024 lds
    buffer_load_dwordx4 v12, s[36:39], s62 offen offset:2048 lds
    buffer_load_dwordx4 v13, s[36:39], s62 offen offset:3072 lds
    s_add_u32 m0, s64, 45056
    s_nop 0
    buffer_load_dwordx4 v14, s[36:39], s62 offen offset:0 lds
    s_add_u32 m0, s65, 10752
    s_sub_u32 s66, s62, 1280
    buffer_load_dwordx4 v15, s[36:39], s66 offen offset:0 lds
    buffer_load_dwordx4 v16, s[36:39], s66 offen offset:1024 lds
    s_mov_b32 exec_hi, 0xff
    buffer_load_dwordx4 v17, s[36:39], s66 offen offset:2048 lds
    s_mov_b32 exec_hi, -1
    s_add_u32 s62, s62, 245760
    s_add_u32 m0, s63, 16384
    s_nop 0
    buffer_load_dwordx4 v6, s[32:35], s61 offen offset:0 lds
    buffer_load_dwordx4 v7, s[32:35], s61 offen offset:1024 lds
    buffer_load_dwordx4 v8, s[32:35], s61 offen offset:2048 lds
    buffer_load_dwordx4 v9, s[32:35], s61 offen offset:3072 lds
    s_add_u32 s61, s61, 128
    s_waitcnt vmcnt(4)
    s_barrier
    s_add_u32 m0, s64, 0
    s_nop 0
    buffer_load_dwordx4 v10, s[36:39], s62 offen offset:0 lds
    buffer_load_dwordx4 v11, s[36:39], s62 offen offset:1024 lds
    buffer_load_dwordx4 v12, s[36:39], s62 offen offset:2048 lds
    buffer_load_dwordx4 v13, s[36:39], s62 offen offset:3072 lds
    s_add_u32 m0, s64, 4096
    s_nop 0
    buffer_load_dwordx4 v14, s[36:39], s62 offen offset:0 lds
    s_add_u32 m0, s65, 21504
    s_sub_u32 s66, s62, 1280
    buffer_load_dwordx4 v15, s[36:39], s66 offen offset:0 lds
    buffer_load_dwordx4 v16, s[36:39], s66 offen offset:1024 lds
    s_mov_b32 exec_hi, 0xff
    buffer_load_dwordx4 v17, s[36:39], s66 offen offset:2048 lds
    s_mov_b32 exec_hi, -1
    s_add_u32 s62, s62, 245760
    s_add_u32 m0, s63, 32768
    s_nop 0
    buffer_load_dwordx4 v6, s[32:35], s61 offen offset:0 lds
    buffer_load_dwordx4 v7, s[32:35], s61 offen offset:1024 lds
    buffer_load_dwordx4 v8, s[32:35], s61 offen offset:2048 lds
    buffer_load_dwordx4 v9, s[32:35], s61 offen offset:3072 lds
    s_add_u32 s61, s61, 128
    s_add_u32 m0, s64, 20480
    s_nop 0
    buffer_load_dwordx4 v10, s[36:39], s62 offen offset:0 lds
    buffer_load_dwordx4 v11, s[36:39], s62 offen offset:1024 lds
    buffer_load_dwordx4 v12, s[36:39], s62 offen offset:2048 lds
    buffer_load_dwordx4 v13, s[36:39], s62 offen offset:3072 lds
    s_add_u32 m0, s64, 24576
    s_nop 0
    buffer_load_dwordx4 v14, s[36:39], s62 offen offset:0 lds
    s_waitcnt vmcnt(9)
    s_barrier
    s_add_u32 m0, s65, 0
    s_sub_u32 s66, s62, 1280
    buffer_load_dwordx4 v15, s[36:39], s66 offen offset:0 lds
    buffer_load_dwordx4 v16, s[36:39], s66 offen offset:1024 lds
    s_mov_b32 exec_hi, 0xff
    buffer_load_dwordx4 v17, s[36:39], s66 offen offset:2048 lds
    s_mov_b32 exec_hi, -1
    s_add_u32 s62, s62, 245760
    s_add_u32 m0, s63, 0
    s_nop 0
    buffer_load_dwordx4 v6, s[32:35], s61 offen offset:0 lds
    buffer_load_dwordx4 v7, s[32:35], s61 offen offset:1024 lds
    buffer_load_dwordx4 v8, s[32:35], s61 offen offset:2048 lds
    buffer_load_dwordx4 v9, s[32:35], s61 offen offset:3072 lds
    s_add_u32 s61, s61, 128
    s_add_u32 m0, s64, 40960
    s_nop 0
    buffer_load_dwordx4 v10, s[36:39], s62 offen offset:0 lds
    buffer_load_dwordx4 v11, s[36:39], s62 offen offset:1024 lds
    buffer_load_dwordx4 v12, s[36:39], s62 offen offset:2048 lds
    buffer_load_dwordx4 v13, s[36:39], s62 offen offset:3072 lds
    s_add_u32 m0, s64, 45056
    s_nop 0
    buffer_load_dwordx4 v14, s[36:39], s62 offen offset:0 lds
    s_add_u32 m0, s65, 10752
    s_sub_u32 s66, s62, 1280
    buffer_load_dwordx4 v15, s[36:39], s66 offen offset:0 lds
    buffer_load_dwordx4 v16, s[36:39], s66 offen offset:1024 lds
    s_mov_b32 exec_hi, 0xff
    buffer_load_dwordx4 v17, s[36:39], s66 offen offset:2048 lds
    s_mov_b32 exec_hi, -1
    s_add_u32 s62, s62, 245760
    s_waitcnt vmcnt(12)
    s_barrier
    s_add_u32 m0, s63, 16384
    s_nop 0
    buffer_load_dwordx4 v6, s[32:35], s61 offen offset:0 lds
    buffer_load_dwordx4 v7, s[32:35], s61 offen offset:1024 lds
    buffer_load_dwordx4 v8, s[32:35], s61 offen offset:2048 lds
    buffer_load_dwordx4 v9, s[32:35], s61 offen offset:3072 lds
    s_add_u32 s61, s61, 128
    s_add_u32 m0, s64, 0
    s_nop 0
    buffer_load_dwordx4 v10, s[36:39], s62 offen offset:0 lds
    buffer_load_dwordx4 v11, s[36:39], s62 offen offset:1024 lds
    buffer_load_dwordx4 v12, s[36:39], s62 offen offset:2048 lds
    buffer_load_dwordx4 v13, s[36:39], s62 offen offset:3072 lds
    s_add_u32 m0, s64, 4096
    s_nop 0
    buffer_load_dwordx4 v14, s[36:39], s62 offen offset:0 lds
    s_add_u32 m0, s65, 21504
    s_sub_u32 s66, s62, 1280
    buffer_load_dwordx4 v15, s[36:39], s66 offen offset:0 lds
    buffer_load_dwordx4 v16, s[36:39], s66 offen offset:1024 lds
    s_mov_b32 exec_hi, 0xff
    buffer_load_dwordx4 v17, s[36:39], s66 offen offset:2048 lds
    s_mov_b32 exec_hi, -1
    s_add_u32 s62, s62, 245760
    s_add_u32 s48, s30, 5316608
    s_addc_u32 s49, s31, 0
    s_mov_b32 s50, 131072
    s_mov_b32 s51, 0x20000
    s_waitcnt vmcnt(12)
    s_barrier
    s_mov_b32 s44, s28
    s_mov_b32 s45, s29
    s_mov_b32 s46, 256
    s_mov_b32 s47, 0x20000
    v_and_b32 v18, 7, v1
    v_lshlrev_b32 v18, 2, v18
    buffer_load_dword v19, v18, s[44:47], 0 offen sc1
    s_add_u32 m0, s63, 32768
    s_nop 0
    buffer_load_dwordx4 v6, s[32:35], s61 offen offset:0 lds
    buffer_load_dwordx4 v7, s[32:35], s61 offen offset:1024 lds
    buffer_load_dwordx4 v8, s[32:35], s61 offen offset:2048 lds
    buffer_load_dwordx4 v9, s[32:35], s61 offen offset:3072 lds
    s_add_u32 s61, s61, 128
    s_add_u32 m0, s64, 20480
    s_nop 0
    buffer_load_dwordx4 v10, s[36:39], s62 offen offset:0 lds
    buffer_load_dwordx4 v11, s[36:39], s62 offen offset:1024 lds
    buffer_load_dwordx4 v12, s[36:39], s62 offen offset:2048 lds
    buffer_load_dwordx4 v13, s[36:39], s62 offen offset:3072 lds
    s_add_u32 m0, s64, 24576
    s_nop 0
    buffer_load_dwordx4 v14, s[36:39], s62 offen offset:0 lds
    s_add_u32 m0, s65, 0
    s_sub_u32 s66, s62, 1280
    buffer_load_dwordx4 v15, s[36:39], s66 offen offset:0 lds
    buffer_load_dwordx4 v16, s[36:39], s66 offen offset:1024 lds
    s_mov_b32 exec_hi, 0xff
    buffer_load_dwordx4 v17, s[36:39], s66 offen offset:2048 lds
    s_mov_b32 exec_hi, -1
    s_add_u32 s62, s62, 245760
    s_waitcnt vmcnt(12)
    s_barrier
    s_add_u32 m0, s63, 0
    s_nop 0
    buffer_load_dwordx4 v6, s[32:35], s61 offen offset:0 lds
    buffer_load_dwordx4 v7, s[32:35], s61 offen offset:1024 lds
    buffer_load_dwordx4 v8, s[32:35], s61 offen offset:2048 lds
    buffer_load_dwordx4 v9, s[32:35], s61 offen offset:3072 lds
    s_add_u32 s61, s61, 128
    s_add_u32 m0, s64, 40960
    s_nop 0
    buffer_load_dwordx4 v10, s[36:39], s62 offen offset:0 lds
    buffer_load_dwordx4 v11, s[36:39], s62 offen offset:1024 lds
    buffer_load_dwordx4 v12, s[36:39], s62 offen offset:2048 lds
    buffer_load_dwordx4 v13, s[36:39], s62 offen offset:3072 lds
    s_add_u32 m0, s64, 45056
    s_nop 0
    buffer_load_dwordx4 v14, s[36:39], s62 offen offset:0 lds
    s_add_u32 m0, s65, 10752
    s_sub_u32 s66, s62, 1280
    buffer_load_dwordx4 v15, s[36:39], s66 offen offset:0 lds
    buffer_load_dwordx4 v16, s[36:39], s66 offen offset:1024 lds
    s_mov_b32 exec_hi, 0xff
    buffer_load_dwordx4 v17, s[36:39], s66 offen offset:2048 lds
    s_mov_b32 exec_hi, -1
    s_add_u32 s62, s62, 245760
    s_waitcnt vmcnt(12)
    s_barrier
    s_add_u32 m0, s63, 16384
    s_nop 0
    buffer_load_dwordx4 v6, s[32:35], s61 offen offset:0 lds
    buffer_load_dwordx4 v7, s[32:35], s61 offen offset:1024 lds
    buffer_load_dwordx4 v8, s[32:35], s61 offen offset:2048 lds
    buffer_load_dwordx4 v9, s[32:35], s61 offen offset:3072 lds
    s_add_u32 s61, s61, 128
    s_add_u32 m0, s64, 0
    s_nop 0
    buffer_load_dwordx4 v10, s[36:39], s62 offen offset:0 lds
    buffer_load_dwordx4 v11, s[36:39], s62 offen offset:1024 lds
    buffer_load_dwordx4 v12, s[36:39], s62 offen offset:2048 lds
    buffer_load_dwordx4 v13, s[36:39], s62 offen offset:3072 lds
    s_add_u32 m0, s64, 4096
    s_nop 0
    buffer_load_dwordx4 v14, s[36:39], s62 offen offset:0 lds
    s_add_u32 m0, s65, 21504
    s_sub_u32 s66, s62, 1280
    buffer_load_dwordx4 v15, s[36:39], s66 offen offset:0 lds
    buffer_load_dwordx4 v16, s[36:39], s66 offen offset:1024 lds
    s_mov_b32 exec_hi, 0xff
    buffer_load_dwordx4 v17, s[36:39], s66 offen offset:2048 lds
    s_mov_b32 exec_hi, -1
    s_add_u32 s62, s62, 245760
    s_waitcnt vmcnt(12)
    s_barrier
    s_setprio 0
    v_cmp_ne_u32 vcc, 1, v19
    s_nop 1
    s_cmp_eq_u64 vcc, 0
    s_cbranch_scc1 zok_3
    s_mov_b32 s44, s28
    s_mov_b32 s45, s29
    s_mov_b32 s46, 256
    s_mov_b32 s47, 0x20000
    v_and_b32 v3, 7, v1
    v_lshlrev_b32 v3, 2, v3
    s_mov_b32 s74, 400000
poll_4:
    buffer_load_dword v4, v3, s[44:47], 0 offen sc1
    s_waitcnt vmcnt(0)
    v_cmp_ne_u32 vcc, 1, v4
    s_sub_u32 s74, s74, 1
    s_cbranch_scc1 polld_5
    s_cmp_eq_u64 vcc, 0
    s_cbranch_scc1 polld_5
    s_sleep 1
    s_branch poll_4
polld_5:
zok_3:
    s_waitcnt vmcnt(0)
    s_barrier
    s_barrier
    s_call_b64 s[72:73], L_WO
    s_barrier
    s_waitcnt vmcnt(0)
    s_barrier
    s_branch L_G2
L_A:
    s_bfe_u32 s54, s59, 0x10002
    s_mul_i32 s54, s54, 5
    s_add_u32 s54, s54, 4
    s_lshr_b32 s4, s58, 2
    s_add_u32 s4, s4, 8
    s_bfe_u32 s56, s58, 0x10001
    s_add_u32 s56, s56, 1
    s_cmp_ge_u32 s59, 24
    s_cselect_b32 s56, 0, s56
    s_cselect_b32 s4, s58, s4
    s_lshl_b32 s4, s4, 6
    s_and_b32 s6, s59, 7
    s_lshl_b32 s6, s6, 3
    s_add_u32 s55, s4, s6
    s_cmp_ge_u32 s59, 24
    s_cbranch_scc1 L_A1
    v_min_u32 v6, 59, v1
    v_mul_u32_u24 v7, 52, v6
    v_lshrrev_b32 v7, 8, v7
    v_mul_u32_u24 v3, 5, v7
    v_sub_u32 v6, v6, v3
    v_lshlrev_b32 v6, 7, v6
    s_movk_i32 s65, 1280
    v_mad_u32_u24 v2, v7, s65, v6
    v_mul_u32_u24 v3, 1280, v1
    s_and_b32 s63, s58, 1
    s_mul_i32 s63, s63, 640
    s_lshl_b32 s60, s3, 3
    s_add_u32 s60, s60, s59
    s_sub_u32 s60, s60, 16
    s_waitcnt lgkmcnt(0)
    s_add_u32 s48, s30, 5316608
    s_addc_u32 s49, s31, 0
    s_mov_b32 s50, 131072
    s_mov_b32 s51, 0x20000
    s_cmp_lg_u32 s60, 63
    s_cbranch_scc1 nozero_6
    s_mul_i32 s64, s58, 8960
    s_add_u32 s64, s64, 5242880
    s_add_u32 s40, s30, s64
    s_addc_u32 s41, s31, 0
    s_mov_b32 s42, 8960
    s_mov_b32 s43, 0x20000
    s_mov_b32 s44, s28
    s_mov_b32 s45, s29
    s_mov_b32 s46, 256
    s_mov_b32 s47, 0x20000
    v_mov_b32 v8, 0
    v_mov_b32 v9, 0
    v_mov_b32 v10, 0
    v_mov_b32 v11, 0
    v_lshlrev_b32 v6, 4, v1
    v_lshlrev_b32 v7, 7, v1
    s_lshl_b32 s64, s58, 13
    buffer_store_dword v8, v7, s[48:51], s64 offen sc1
    s_add_u32 s64, s64, 0x10000
    buffer_store_dword v8, v7, s[48:51], s64 offen sc1
    s_movk_i32 s64, 4096
    s_movk_i32 s65, 8192
    buffer_store_dwordx4 v[8:11], v6, s[40:43], 0 offen offset:0 sc1
    buffer_store_dwordx4 v[8:11], v6, s[40:43], 0 offen offset:1024 sc1
    buffer_store_dwordx4 v[8:11], v6, s[40:43], 0 offen offset:2048 sc1
    buffer_store_dwordx4 v[8:11], v6, s[40:43], 0 offen offset:3072 sc1
    buffer_store_dwordx4 v[8:11], v6, s[40:43], s64 offen offset:0 sc1
    buffer_store_dwordx4 v[8:11], v6, s[40:43], s64 offen offset:1024 sc1
    buffer_store_dwordx4 v[8:11], v6, s[40:43], s64 offen offset:2048 sc1
    buffer_store_dwordx4 v[8:11], v6, s[40:43], s64 offen offset:3072 sc1
    buffer_store_dwordx4 v[8:11], v6, s[40:43], s65 offen offset:0 sc1
    s_lshl_b32 s64, s58, 2
    v_mov_b32 v7, 1
    s_waitcnt vmcnt(0)
    s_mov_b64 exec, 1
    buffer_store_dword v7, v6, s[44:47], s64 offen sc1
    s_mov_b64 exec, -1
nozero_6:
    s_cmp_lg_u32 s60, 62
    s_cbranch_scc1 notlb_7
    v_lshlrev_b32 v7, 20, v1
    s_mov_b32 s32, s30
    s_mov_b32 s33, s31
    s_mov_b32 s34, 5447680
    s_mov_b32 s35, 0x20000
    buffer_load_dword v236, v7, s[32:35], 0 offen
    s_mov_b32 s32, s26
    s_mov_b32 s33, s27
    s_mov_b32 s34, 5242880
    s_mov_b32 s35, 0x20000
    buffer_load_dword v237, v7, s[32:35], 0 offen
    s_mov_b32 s32, s8
    s_mov_b32 s33, s9
    s_mov_b32 s34, 2621440
    s_mov_b32 s35, 0x20000
    buffer_load_dword v238, v7, s[32:35], 0 offen
    s_mov_b32 s32, s24
    s_mov_b32 s33, s25
    s_mov_b32 s34, 819200
    s_mov_b32 s35, 0x20000
    buffer_load_dword v239, v7, s[32:35], 0 offen
    s_mov_b32 s32, s28
    s_mov_b32 s33, s29
    s_mov_b32 s34, 256
    s_mov_b32 s35, 0x20000
    buffer_load_dword v240, v7, s[32:35], 0 offen
    s_mov_b32 s32, s16
    s_mov_b32 s33, s17
    s_mov_b32 s34, 2621440
    s_mov_b32 s35, 0x20000
    buffer_load_dword v241, v7, s[32:35], 0 offen
notlb_7:
    s_mov_b32 s32, s20
    s_mov_b32 s33, s21
    s_mov_b32 s34, 2621440
    s_mov_b32 s35, 0x20000
    s_mov_b32 s36, s22
    s_mov_b32 s37, s23
    s_mov_b32 s38, 2457600
    s_mov_b32 s39, 0x20000
    s_add_u32 s64, s60, 0
    s_mul_i32 s61, s64, 2731
    s_lshr_b32 s61, s61, 16
    s_mul_i32 s62, s61, 24
    s_sub_u32 s62, s64, s62
    s_add_u32 s61, s61, 1
    s_cmp_lt_u32 s62, 8
    s_cbranch_scc1 px_10
    s_sub_u32 s62, s62, 8
    s_lshl_b32 s62, s62, 2
    s_lshl_b32 s61, s61, 6
    s_add_u32 s61, s61, s62
    s_mul_i32 s61, s61, 3840
    s_add_u32 s61, s61, s63
    buffer_load_dword v244, v2, s[36:39], s61 offen
    s_branch pe_11
px_10:
    s_lshr_b32 s65, s58, 1
    s_lshl_b32 s65, s65, 3
    s_add_u32 s62, s62, s65
    s_mul_i32 s62, s62, 81920
    s_lshl_b32 s61, s61, 7
    s_add_u32 s61, s61, s62
    buffer_load_dword v244, v3, s[32:35], s61 offen
pe_11:
    s_barrier
    s_add_u32 s64, s60, 64
    s_mul_i32 s61, s64, 2731
    s_lshr_b32 s61, s61, 16
    s_mul_i32 s62, s61, 24
    s_sub_u32 s62, s64, s62
    s_add_u32 s61, s61, 1
    s_cmp_lt_u32 s62, 8
    s_cbranch_scc1 px_12
    s_sub_u32 s62, s62, 8
    s_lshl_b32 s62, s62, 2
    s_lshl_b32 s61, s61, 6
    s_add_u32 s61, s61, s62
    s_mul_i32 s61, s61, 3840
    s_add_u32 s61, s61, s63
    buffer_load_dword v245, v2, s[36:39], s61 offen
    s_branch pe_13
px_12:
    s_lshr_b32 s65, s58, 1
    s_lshl_b32 s65, s65, 3
    s_add_u32 s62, s62, s65
    s_mul_i32 s62, s62, 81920
    s_lshl_b32 s61, s61, 7
    s_add_u32 s61, s61, s62
    buffer_load_dword v245, v3, s[32:35], s61 offen
pe_13:
    s_barrier
    s_add_u32 s64, s60, 128
    s_mul_i32 s61, s64, 2731
    s_lshr_b32 s61, s61, 16
    s_mul_i32 s62, s61, 24
    s_sub_u32 s62, s64, s62
    s_add_u32 s61, s61, 1
    s_cmp_lt_u32 s62, 8
    s_cbranch_scc1 px_14
    s_sub_u32 s62, s62, 8
    s_lshl_b32 s62, s62, 2
    s_lshl_b32 s61, s61, 6
    s_add_u32 s61, s61, s62
    s_mul_i32 s61, s61, 3840
    s_add_u32 s61, s61, s63
    buffer_load_dword v246, v2, s[36:39], s61 offen
    s_branch pe_15
px_14:
    s_lshr_b32 s65, s58, 1
    s_lshl_b32 s65, s65, 3
    s_add_u32 s62, s62, s65
    s_mul_i32 s62, s62, 81920
    s_lshl_b32 s61, s61, 7
    s_add_u32 s61, s61, s62
    buffer_load_dword v246, v3, s[32:35], s61 offen
pe_15:
    s_barrier
    s_add_u32 s64, s60, 192
    s_cmp_ge_u32 s64, 216
    s_cbranch_scc1 pfd_9
    s_mul_i32 s61, s64, 2731
    s_lshr_b32 s61, s61, 16
    s_mul_i32 s62, s61, 24
    s_sub_u32 s62, s64, s62
    s_add_u32 s61, s61, 1
    s_cmp_lt_u32 s62, 8
    s_cbranch_scc1 px_16
    s_sub_u32 s62, s62, 8
    s_lshl_b32 s62, s62, 2
    s_lshl_b32 s61, s61, 6
    s_add_u32 s61, s61, s62
    s_mul_i32 s61, s61, 3840
    s_add_u32 s61, s61, s63
    buffer_load_dword v247, v2, s[36:39], s61 offen
    s_branch pe_17
px_16:
    s_lshr_b32 s65, s58, 1
    s_lshl_b32 s65, s65, 3
    s_add_u32 s62, s62, s65
    s_mul_i32 s62, s62, 81920
    s_lshl_b32 s61, s61, 7
    s_add_u32 s61, s61, s62
    buffer_load_dword v247, v3, s[32:35], s61 offen
pe_17:
pfd_9:
    s_barrier
    s_mov_b32 s36, s16
    s_mov_b32 s37, s17
    s_mov_b32 s38, 2621440
    s_mov_b32 s39, 0x20000
    s_cmp_ge_u32 s60, 32
    s_cbranch_scc1 pnh_18
    s_and_b32 s61, s58, 3
    s_cbranch_scc0 pnh_18
    s_mul_i32 s61, s58, 262144
    s_lshl_b32 s62, s60, 13
    s_add_u32 s61, s61, s62
    v_lshlrev_b32 v6, 7, v1
    buffer_load_dword v249, v6, s[36:39], s61 offen
pnh_18:
    s_mov_b32 s32, s24
    s_mov_b32 s33, s25
    s_mov_b32 s34, 819200
    s_mov_b32 s35, 0x20000
    s_mul_i32 s61, s60, 15360
    s_add_u32 s61, s61, s63
    buffer_load_dword v248, v2, s[32:35], s61 offen
    s_mov_b32 s36, s8
    s_mov_b32 s37, s9
    s_mov_b32 s38, 2621440
    s_mov_b32 s39, 0x20000
    s_and_b32 s61, s58, 1
    s_cbranch_scc0 pnqq_19
    s_lshl_b32 s60, s3, 3
    s_add_u32 s60, s60, s59
    s_sub_u32 s60, s60, 16
    s_cmp_lt_u32 s60, 32
    s_cbranch_scc1 pq2_21
    s_xor_b32 s61, s60, 48
    s_mul_i32 s61, s61, 81920
    s_lshl_b32 s62, s58, 7
    s_add_u32 s61, s61, s62
    buffer_load_dword v250, v3, s[36:39], s61 offen
    s_branch pnq_20
pq2_21:
    s_and_b32 s61, s58, 1
    s_cbranch_scc1 pnq_20
    s_cmp_lt_u32 s60, 16
    s_cbranch_scc1 pnq_20
    s_and_b32 s62, s56, 2
    s_lshl_b32 s62, s62, 3
    s_xor_b32 s61, s60, s62
    s_mul_i32 s61, s61, 81920
    s_lshl_b32 s62, s55, 1
    s_add_u32 s61, s61, s62
    buffer_load_dword v250, v3, s[36:39], s61 offen
pnq_20:
pnqq_19:
    s_add_u32 s6, s55, s3
    s_min_u32 s6, s6, 639
    s_lshl_b32 s6, s6, 1
    s_and_b32 s6, s6, 0xfffffffc
    s_load_dword s5, s[18:19], s6
    s_cmp_lg_u32 s3, 1
    s_cbranch_scc1 pnz_22
    s_mov_b32 s44, s28
    s_mov_b32 s45, s29
    s_mov_b32 s46, 256
    s_mov_b32 s47, 0x20000
    v_and_b32 v6, 7, v1
    v_lshlrev_b32 v6, 2, v6
    s_mov_b32 s74, 400000
poll_23:
    buffer_load_dword v7, v6, s[44:47], 0 offen sc1
    s_waitcnt vmcnt(0)
    v_cmp_ne_u32 vcc, 1, v7
    s_sub_u32 s74, s74, 1
    s_cbranch_scc1 polld_24
    s_cmp_eq_u64 vcc, 0
    s_cbranch_scc1 polld_24
    s_sleep 1
    s_branch poll_23
polld_24:
pnz_22:
    s_waitcnt lgkmcnt(0)
    s_and_b32 s60, s58, 1
    s_cbranch_scc0 L_CONV
    s_add_u32 s36, s30, 2621440
    s_addc_u32 s37, s31, 0
    s_mov_b32 s38, 2621440
    s_mov_b32 s39, 0x20000
    s_cmp_lt_u32 s3, 4
    s_cbranch_scc1 L_JB
    s_waitcnt vmcnt(0)
    s_call_b64 s[72:73], L_WO
L_JB:
    s_waitcnt vmcnt(0)
    s_barrier
    s_branch L_G2
L_A1:
    s_sub_u32 s64, s59, 24
    s_lshl_b32 s64, s64, 3
    s_add_u32 s64, s64, s58
    s_lshr_b32 s60, s64, 1
    s_and_b32 s61, s64, 1
    s_lshl_b32 s57, s61, 5
    s_add_u32 s57, s57, s60
    s_mov_b32 s67, s3
    s_lshl_b32 s64, s60, 3
    s_add_u32 s64, s64, s3
    s_mul_i32 s62, s64, 10240
    s_mul_i32 s64, s61, 640
    s_add_u32 s62, s62, s64
    s_mul_i32 s63, s3, 5120
    s_and_b32 s64, s3, 1
    s_lshl_b32 s64, s64, 2
    s_movk_i32 s66, 1280
    v_mul_u32_u24 v3, 1639, v1
    v_lshrrev_b32 v3, 16, v3
    v_mul_u32_u24 v4, 40, v3
    v_sub_u32 v2, v1, v4
    v_and_or_b32 v4, v3, 2, s64
    v_xor_b32 v2, v2, v4
    v_lshlrev_b32 v2, 4, v2
    v_mad_u32_u24 v5, v3, s66, v2
    v_add_u32 v2, 64, v1
    v_mul_u32_u24 v3, 1639, v2
    v_lshrrev_b32 v3, 16, v3
    v_mul_u32_u24 v4, 40, v3
    v_sub_u32 v2, v2, v4
    v_and_or_b32 v4, v3, 2, s64
    v_xor_b32 v2, v2, v4
    v_lshlrev_b32 v2, 4, v2
    v_mad_u32_u24 v2, v3, s66, v2
    v_subrev_u32 v6, 1024, v2
    s_waitcnt lgkmcnt(0)
    s_mov_b32 s32, s10
    s_mov_b32 s33, s11
    s_mov_b32 s34, 2621440
    s_mov_b32 s35, 0x20000
    s_mov_b32 s36, s12
    s_mov_b32 s37, s13
    s_mov_b32 s38, 2621440
    s_mov_b32 s39, 0x20000
    s_add_u32 m0, s63, 71680
    s_nop 0
    buffer_load_dwordx4 v5, s[32:35], s62 offen offset:0 lds
    s_add_u32 m0, s63, 112640
    s_nop 0
    buffer_load_dwordx4 v5, s[36:39], s62 offen offset:0 lds
    s_add_u32 m0, s63, 71680
    s_nop 0
    buffer_load_dwordx4 v6, s[32:35], s62 offen offset:1024 lds
    s_add_u32 m0, s63, 112640
    s_nop 0
    buffer_load_dwordx4 v6, s[36:39], s62 offen offset:1024 lds
    s_mov_b32 s44, s14
    s_mov_b32 s45, s15
    s_mov_b32 s46, 5120
    s_mov_b32 s47, 0x20000
    v_and_b32 v10, 15, v1
    s_mul_i32 s65, s61, 320
    v_add_u32 v14, s65, v10
    v_lshlrev_b32 v15, 3, v14
    s_lshl_b32 s65, s67, 7
    buffer_load_dwordx2 v[16:17], v15, s[44:47], s65 offen offset:0
    buffer_load_dwordx2 v[18:19], v15, s[44:47], s65 offen offset:1024
    buffer_load_dwordx2 v[20:21], v15, s[44:47], s65 offen offset:2048
    v_add_u32 v2, 128, v1
    v_mul_u32_u24 v3, 1639, v2
    v_lshrrev_b32 v3, 16, v3
    v_mul_u32_u24 v4, 40, v3
    v_sub_u32 v2, v2, v4
    v_and_or_b32 v4, v3, 2, s64
    v_xor_b32 v2, v2, v4
    v_lshlrev_b32 v2, 4, v2
    v_mad_u32_u24 v2, v3, s66, v2
    v_subrev_u32 v7, 2048, v2
    s_add_u32 m0, s63, 71680
    s_nop 0
    buffer_load_dwordx4 v7, s[32:35], s62 offen offset:2048 lds
    s_add_u32 m0, s63, 112640
    s_nop 0
    buffer_load_dwordx4 v7, s[36:39], s62 offen offset:2048 lds
    v_add_u32 v2, 192, v1
    v_mul_u32_u24 v3, 1639, v2
    v_lshrrev_b32 v3, 16, v3
    v_mul_u32_u24 v4, 40, v3
    v_sub_u32 v2, v2, v4
    v_and_or_b32 v4, v3, 2, s64
    v_xor_b32 v2, v2, v4
    v_lshlrev_b32 v2, 4, v2
    v_mad_u32_u24 v2, v3, s66, v2
    v_subrev_u32 v8, 3072, v2
    s_add_u32 m0, s63, 71680
    s_nop 0
    buffer_load_dwordx4 v8, s[32:35], s62 offen offset:3072 lds
    s_add_u32 m0, s63, 112640
    s_nop 0
    buffer_load_dwordx4 v8, s[36:39], s62 offen offset:3072 lds
    v_add_u32 v2, 256, v1
    v_mul_u32_u24 v3, 1639, v2
    v_lshrrev_b32 v3, 16, v3
    v_mul_u32_u24 v4, 40, v3
    v_sub_u32 v2, v2, v4
    v_and_or_b32 v4, v3, 2, s64
    v_xor_b32 v2, v2, v4
    v_lshlrev_b32 v2, 4, v2
    v_mad_u32_u24 v9, v3, s66, v2
    s_add_u32 m0, s63, 75776
    s_nop 0
    buffer_load_dwordx4 v9, s[32:35], s62 offen offset:0 lds
    s_add_u32 m0, s63, 116736
    s_nop 0
    buffer_load_dwordx4 v9, s[36:39], s62 offen offset:0 lds
    s_cmp_lg_u32 s3, 7
    s_cbranch_scc1 a1_nohalo_25
    s_sub_u32 s65, s62, 81920
    s_cmp_eq_u32 s60, 0
    s_cselect_b32 s65, 2621440, s65
    s_add_u32 m0, s63, 30720
    s_nop 0
    buffer_load_dwordx4 v7, s[32:35], s65 offen offset:2048 lds
    s_add_u32 m0, s63, 30720
    s_nop 0
    buffer_load_dwordx4 v8, s[32:35], s65 offen offset:3072 lds
    s_add_u32 m0, s63, 34816
    s_nop 0
    buffer_load_dwordx4 v9, s[32:35], s65 offen offset:0 lds
a1_nohalo_25:
    s_mov_b32 s32, s16
    s_mov_b32 s33, s17
    s_mov_b32 s34, 2621440
    s_mov_b32 s35, 0x20000
    s_add_u32 s68, s55, s3
    s_lshl_b32 s68, s68, 12
    v_lshlrev_b32 v244, 4, v1
    s_mov_b32 s44, s28
    s_mov_b32 s45, s29
    s_mov_b32 s46, 256
    s_mov_b32 s47, 0x20000
    v_and_b32 v136, 7, v1
    v_lshlrev_b32 v136, 2, v136
    s_mov_b32 s40, s30
    s_mov_b32 s41, s31
    s_mov_b32 s42, 2621440
    s_mov_b32 s43, 0x20000
    s_add_u32 s48, s30, 5316608
    s_addc_u32 s49, s31, 0
    s_mov_b32 s50, 131072
    s_mov_b32 s51, 0x20000
    s_add_u32 s6, s55, s3
    s_min_u32 s6, s6, 639
    s_lshl_b32 s6, s6, 1
    s_and_b32 s6, s6, 0xfffffffc
    s_load_dword s5, s[18:19], s6
    v_lshrrev_b32 v11, 4, v1
    v_lshrrev_b32 v2, 2, v10
    v_lshl_add_u32 v3, v11, 3, v2
    v_mul_u32_u24 v12, 640, v3
    v_and_b32 v4, 3, v10
    v_lshl_add_u32 v12, v4, 3, v12
    v_add_u32 v12, 71680, v12
    v_lshrrev_b32 v2, 1, v2
    v_and_b32 v3, 1, v11
    v_lshl_or_b32 v2, v3, 1, v2
    v_xor_b32 v2, s67, v2
    v_lshlrev_b32 v2, 5, v2
    v_xor_b32 v3, 64, v2
    v_add_u32 v13, v3, v12
    v_subrev_u32 v13, 2560, v13
    v_add_u32 v12, v2, v12
    v_and_b32 v2, 0xfffffff7, v14
    v_lshlrev_b32 v2, 12, v2
    s_lshl_b32 s64, s60, 7
    v_lshlrev_b32 v3, 4, v11
    v_add_u32 v3, s64, v3
    v_and_b32 v4, 8, v10
    v_lshl_add_u32 v3, v4, 3, v3
    v_sub_u32 v14, 4080, v3
    v_add_u32 v14, v14, v2
    s_lshl_b32 s66, s67, 16
    s_waitcnt vmcnt(6)
    v_alignbit_b32 v82, v16, v16, 16
    v_alignbit_b32 v83, v17, v17, 16
    v_and_b32 v84, 0xffff0000, v16
    v_and_b32 v85, 0xffff, v16
    v_and_b32 v86, 0xffff, v17
    v_or_b32 v84, v84, v86
    v_and_b32 v86, 0xffff0000, v17
    v_alignbit_b32 v88, v18, v18, 16
    v_alignbit_b32 v89, v19, v19, 16
    v_and_b32 v90, 0xffff0000, v18
    v_and_b32 v91, 0xffff, v18
    v_and_b32 v92, 0xffff, v19
    v_or_b32 v90, v90, v92
    v_and_b32 v92, 0xffff0000, v19
    v_alignbit_b32 v94, v20, v20, 16
    v_alignbit_b32 v95, v21, v21, 16
    v_and_b32 v96, 0xffff0000, v20
    v_and_b32 v97, 0xffff, v20
    v_and_b32 v98, 0xffff, v21
    v_or_b32 v96, v96, v98
    v_and_b32 v98, 0xffff0000, v21
    s_waitcnt vmcnt(0) lgkmcnt(0)
    s_barrier
    buffer_load_dword v136, v136, s[44:47], 0 offen sc1
    ds_read_b64_tr_b16 v[22:23], v13 offset:0
    ds_read_b64_tr_b16 v[24:25], v12 offset:0
    ds_read_b64_tr_b16 v[26:27], v12 offset:2560
    ds_read_b64_tr_b16 v[58:59], v12 offset:40960
    ds_read_b64_tr_b16 v[60:61], v12 offset:43520
    ds_read_b64_tr_b16 v[28:29], v13 offset:20480
    ds_read_b64_tr_b16 v[30:31], v12 offset:20480
    ds_read_b64_tr_b16 v[32:33], v12 offset:23040
    ds_read_b64_tr_b16 v[62:63], v12 offset:61440
    ds_read_b64_tr_b16 v[64:65], v12 offset:64000
    ds_read_b64_tr_b16 v[34:35], v13 offset:256
    ds_read_b64_tr_b16 v[36:37], v12 offset:256
    ds_read_b64_tr_b16 v[38:39], v12 offset:2816
    ds_read_b64_tr_b16 v[66:67], v12 offset:41216
    ds_read_b64_tr_b16 v[68:69], v12 offset:43776
    s_waitcnt lgkmcnt(10)
    ds_read_b64_tr_b16 v[40:41], v13 offset:20736
    ds_read_b64_tr_b16 v[42:43], v12 offset:20736
    ds_read_b64_tr_b16 v[44:45], v12 offset:23296
    ds_read_b64_tr_b16 v[70:71], v12 offset:61696
    ds_read_b64_tr_b16 v[72:73], v12 offset:64256
    v_dot2_f32_bf16 v100, v22, v86, 0
    v_dot2_f32_bf16 v101, v23, v83, 0
    v_dot2_f32_bf16 v102, v23, v86, 0
    v_dot2_f32_bf16 v103, v24, v83, 0
    v_dot2_f32_bf16 v104, v24, v86, 0
    v_dot2_f32_bf16 v105, v25, v83, 0
    v_dot2_f32_bf16 v106, v25, v86, 0
    v_dot2_f32_bf16 v107, v26, v83, 0
    v_dot2_f32_bf16 v100, v23, v84, v100
    v_dot2_f32_bf16 v101, v24, v82, v101
    v_dot2_f32_bf16 v102, v24, v84, v102
    v_dot2_f32_bf16 v103, v25, v82, v103
    v_dot2_f32_bf16 v104, v25, v84, v104
    v_dot2_f32_bf16 v105, v26, v82, v105
    v_dot2_f32_bf16 v106, v26, v84, v106
    v_dot2_f32_bf16 v107, v27, v82, v107
    v_dot2_f32_bf16 v100, v24, v85, v100
    v_dot2_f32_bf16 v102, v25, v85, v102
    v_dot2_f32_bf16 v104, v26, v85, v104
    v_dot2_f32_bf16 v106, v27, v85, v106
    v_lshlrev_b32 v132, 16, v58
    v_and_b32 v133, 0xffff0000, v58
    v_mul_f32 v133, v133, v101
    v_mul_f32 v132, v132, v100
    v_cvt_pk_bf16_f32 v111, v133, v132
    v_lshlrev_b32 v134, 16, v59
    v_and_b32 v135, 0xffff0000, v59
    v_mul_f32 v135, v135, v103
    v_mul_f32 v134, v134, v102
    v_cvt_pk_bf16_f32 v110, v135, v134
    v_lshlrev_b32 v132, 16, v60
    v_and_b32 v133, 0xffff0000, v60
    v_mul_f32 v133, v133, v105
    v_mul_f32 v132, v132, v104
    v_cvt_pk_bf16_f32 v109, v133, v132
    v_lshlrev_b32 v134, 16, v61
    v_and_b32 v135, 0xffff0000, v61
    v_mul_f32 v135, v135, v107
    v_mul_f32 v134, v134, v106
    v_cvt_pk_bf16_f32 v108, v135, v134
    s_waitcnt lgkmcnt(10)
    ds_read_b64_tr_b16 v[46:47], v13 offset:512
    ds_read_b64_tr_b16 v[48:49], v12 offset:512
    ds_read_b64_tr_b16 v[50:51], v12 offset:3072
    ds_read_b64_tr_b16 v[74:75], v12 offset:41472
    ds_read_b64_tr_b16 v[76:77], v12 offset:44032
    v_dot2_f32_bf16 v100, v28, v86, 0
    v_dot2_f32_bf16 v101, v29, v83, 0
    v_dot2_f32_bf16 v102, v29, v86, 0
    v_dot2_f32_bf16 v103, v30, v83, 0
    v_dot2_f32_bf16 v104, v30, v86, 0
    v_dot2_f32_bf16 v105, v31, v83, 0
    v_dot2_f32_bf16 v106, v31, v86, 0
    v_dot2_f32_bf16 v107, v32, v83, 0
    v_dot2_f32_bf16 v100, v29, v84, v100
    v_dot2_f32_bf16 v101, v30, v82, v101
    v_dot2_f32_bf16 v102, v30, v84, v102
    v_dot2_f32_bf16 v103, v31, v82, v103
    v_dot2_f32_bf16 v104, v31, v84, v104
    v_dot2_f32_bf16 v105, v32, v82, v105
    v_dot2_f32_bf16 v106, v32, v84, v106
    v_dot2_f32_bf16 v107, v33, v82, v107
    v_dot2_f32_bf16 v100, v30, v85, v100
    v_dot2_f32_bf16 v102, v31, v85, v102
    v_dot2_f32_bf16 v104, v32, v85, v104
    v_dot2_f32_bf16 v106, v33, v85, v106
    v_lshlrev_b32 v132, 16, v62
    v_and_b32 v133, 0xffff0000, v62
    v_mul_f32 v133, v133, v101
    v_mul_f32 v132, v132, v100
    v_cvt_pk_bf16_f32 v115, v133, v132
    v_lshlrev_b32 v134, 16, v63
    v_and_b32 v135, 0xffff0000, v63
    v_mul_f32 v135, v135, v103
    v_mul_f32 v134, v134, v102
    v_cvt_pk_bf16_f32 v114, v135, v134
    v_lshlrev_b32 v132, 16, v64
    v_and_b32 v133, 0xffff0000, v64
    v_mul_f32 v133, v133, v105
    v_mul_f32 v132, v132, v104
    v_cvt_pk_bf16_f32 v113, v133, v132
    v_lshlrev_b32 v134, 16, v65
    v_and_b32 v135, 0xffff0000, v65
    v_mul_f32 v135, v135, v107
    v_mul_f32 v134, v134, v106
    v_cvt_pk_bf16_f32 v112, v135, v134
    v_mov_b32 v132, v108
    v_mov_b32 v133, v109
    v_mov_b32 v134, v110
    v_mov_b32 v135, v111
    v_mov_b32_dpp v111, v115 row_ror:8 row_mask:0xf bank_mask:0xc
    v_mov_b32_dpp v110, v114 row_ror:8 row_mask:0xf bank_mask:0xc
    v_mov_b32_dpp v109, v113 row_ror:8 row_mask:0xf bank_mask:0xc
    v_mov_b32_dpp v108, v112 row_ror:8 row_mask:0xf bank_mask:0xc
    v_mov_b32_dpp v112, v132 row_ror:8 row_mask:0xf bank_mask:0x3
    v_mov_b32_dpp v113, v133 row_ror:8 row_mask:0xf bank_mask:0x3
    v_mov_b32_dpp v114, v134 row_ror:8 row_mask:0xf bank_mask:0x3
    v_mov_b32_dpp v115, v135 row_ror:8 row_mask:0xf bank_mask:0x3
    buffer_store_dwordx4 v[108:111], v14, s[40:43], s66 offen sc1
    s_add_u32 s64, s66, 32768
    buffer_store_dwordx4 v[112:115], v14, s[40:43], s64 offen sc1
    s_add_u32 s66, s66, 524288
    s_waitcnt lgkmcnt(10)
    ds_read_b64_tr_b16 v[52:53], v13 offset:20992
    ds_read_b64_tr_b16 v[54:55], v12 offset:20992
    ds_read_b64_tr_b16 v[56:57], v12 offset:23552
    ds_read_b64_tr_b16 v[78:79], v12 offset:61952
    ds_read_b64_tr_b16 v[80:81], v12 offset:64512
    v_dot2_f32_bf16 v100, v34, v92, 0
    v_dot2_f32_bf16 v101, v35, v89, 0
    v_dot2_f32_bf16 v102, v35, v92, 0
    v_dot2_f32_bf16 v103, v36, v89, 0
    v_dot2_f32_bf16 v104, v36, v92, 0
    v_dot2_f32_bf16 v105, v37, v89, 0
    v_dot2_f32_bf16 v106, v37, v92, 0
    v_dot2_f32_bf16 v107, v38, v89, 0
    v_dot2_f32_bf16 v100, v35, v90, v100
    v_dot2_f32_bf16 v101, v36, v88, v101
    v_dot2_f32_bf16 v102, v36, v90, v102
    v_dot2_f32_bf16 v103, v37, v88, v103
    v_dot2_f32_bf16 v104, v37, v90, v104
    v_dot2_f32_bf16 v105, v38, v88, v105
    v_dot2_f32_bf16 v106, v38, v90, v106
    v_dot2_f32_bf16 v107, v39, v88, v107
    v_dot2_f32_bf16 v100, v36, v91, v100
    v_dot2_f32_bf16 v102, v37, v91, v102
    v_dot2_f32_bf16 v104, v38, v91, v104
    v_dot2_f32_bf16 v106, v39, v91, v106
    v_lshlrev_b32 v132, 16, v66
    v_and_b32 v133, 0xffff0000, v66
    v_mul_f32 v133, v133, v101
    v_mul_f32 v132, v132, v100
    v_cvt_pk_bf16_f32 v119, v133, v132
    v_lshlrev_b32 v134, 16, v67
    v_and_b32 v135, 0xffff0000, v67
    v_mul_f32 v135, v135, v103
    v_mul_f32 v134, v134, v102
    v_cvt_pk_bf16_f32 v118, v135, v134
    v_lshlrev_b32 v132, 16, v68
    v_and_b32 v133, 0xffff0000, v68
    v_mul_f32 v133, v133, v105
    v_mul_f32 v132, v132, v104
    v_cvt_pk_bf16_f32 v117, v133, v132
    v_lshlrev_b32 v134, 16, v69
    v_and_b32 v135, 0xffff0000, v69
    v_mul_f32 v135, v135, v107
    v_mul_f32 v134, v134, v106
    v_cvt_pk_bf16_f32 v116, v135, v134
    s_waitcnt lgkmcnt(10)
    v_dot2_f32_bf16 v100, v40, v92, 0
    v_dot2_f32_bf16 v101, v41, v89, 0
    v_dot2_f32_bf16 v102, v41, v92, 0
    v_dot2_f32_bf16 v103, v42, v89, 0
    v_dot2_f32_bf16 v104, v42, v92, 0
    v_dot2_f32_bf16 v105, v43, v89, 0
    v_dot2_f32_bf16 v106, v43, v92, 0
    v_dot2_f32_bf16 v107, v44, v89, 0
    v_dot2_f32_bf16 v100, v41, v90, v100
    v_dot2_f32_bf16 v101, v42, v88, v101
    v_dot2_f32_bf16 v102, v42, v90, v102
    v_dot2_f32_bf16 v103, v43, v88, v103
    v_dot2_f32_bf16 v104, v43, v90, v104
    v_dot2_f32_bf16 v105, v44, v88, v105
    v_dot2_f32_bf16 v106, v44, v90, v106
    v_dot2_f32_bf16 v107, v45, v88, v107
    v_dot2_f32_bf16 v100, v42, v91, v100
    v_dot2_f32_bf16 v102, v43, v91, v102
    v_dot2_f32_bf16 v104, v44, v91, v104
    v_dot2_f32_bf16 v106, v45, v91, v106
    v_lshlrev_b32 v132, 16, v70
    v_and_b32 v133, 0xffff0000, v70
    v_mul_f32 v133, v133, v101
    v_mul_f32 v132, v132, v100
    v_cvt_pk_bf16_f32 v123, v133, v132
    v_lshlrev_b32 v134, 16, v71
    v_and_b32 v135, 0xffff0000, v71
    v_mul_f32 v135, v135, v103
    v_mul_f32 v134, v134, v102
    v_cvt_pk_bf16_f32 v122, v135, v134
    v_lshlrev_b32 v132, 16, v72
    v_and_b32 v133, 0xffff0000, v72
    v_mul_f32 v133, v133, v105
    v_mul_f32 v132, v132, v104
    v_cvt_pk_bf16_f32 v121, v133, v132
    v_lshlrev_b32 v134, 16, v73
    v_and_b32 v135, 0xffff0000, v73
    v_mul_f32 v135, v135, v107
    v_mul_f32 v134, v134, v106
    v_cvt_pk_bf16_f32 v120, v135, v134
    v_mov_b32 v132, v116
    v_mov_b32 v133, v117
    v_mov_b32 v134, v118
    v_mov_b32 v135, v119
    v_mov_b32_dpp v119, v123 row_ror:8 row_mask:0xf bank_mask:0xc
    v_mov_b32_dpp v118, v122 row_ror:8 row_mask:0xf bank_mask:0xc
    v_mov_b32_dpp v117, v121 row_ror:8 row_mask:0xf bank_mask:0xc
    v_mov_b32_dpp v116, v120 row_ror:8 row_mask:0xf bank_mask:0xc
    v_mov_b32_dpp v120, v132 row_ror:8 row_mask:0xf bank_mask:0x3
    v_mov_b32_dpp v121, v133 row_ror:8 row_mask:0xf bank_mask:0x3
    v_mov_b32_dpp v122, v134 row_ror:8 row_mask:0xf bank_mask:0x3
    v_mov_b32_dpp v123, v135 row_ror:8 row_mask:0xf bank_mask:0x3
    buffer_store_dwordx4 v[116:119], v14, s[40:43], s66 offen sc1
    s_add_u32 s64, s66, 32768
    buffer_store_dwordx4 v[120:123], v14, s[40:43], s64 offen sc1
    s_add_u32 s66, s66, 524288
    s_cmp_ge_u32 s3, 4
    s_cbranch_scc1 a1_done_26
    s_waitcnt lgkmcnt(5)
    v_dot2_f32_bf16 v100, v46, v98, 0
    v_dot2_f32_bf16 v101, v47, v95, 0
    v_dot2_f32_bf16 v102, v47, v98, 0
    v_dot2_f32_bf16 v103, v48, v95, 0
    v_dot2_f32_bf16 v104, v48, v98, 0
    v_dot2_f32_bf16 v105, v49, v95, 0
    v_dot2_f32_bf16 v106, v49, v98, 0
    v_dot2_f32_bf16 v107, v50, v95, 0
    v_dot2_f32_bf16 v100, v47, v96, v100
    v_dot2_f32_bf16 v101, v48, v94, v101
    v_dot2_f32_bf16 v102, v48, v96, v102
    v_dot2_f32_bf16 v103, v49, v94, v103
    v_dot2_f32_bf16 v104, v49, v96, v104
    v_dot2_f32_bf16 v105, v50, v94, v105
    v_dot2_f32_bf16 v106, v50, v96, v106
    v_dot2_f32_bf16 v107, v51, v94, v107
    v_dot2_f32_bf16 v100, v48, v97, v100
    v_dot2_f32_bf16 v102, v49, v97, v102
    v_dot2_f32_bf16 v104, v50, v97, v104
    v_dot2_f32_bf16 v106, v51, v97, v106
    v_lshlrev_b32 v132, 16, v74
    v_and_b32 v133, 0xffff0000, v74
    v_mul_f32 v133, v133, v101
    v_mul_f32 v132, v132, v100
    v_cvt_pk_bf16_f32 v127, v133, v132
    v_lshlrev_b32 v134, 16, v75
    v_and_b32 v135, 0xffff0000, v75
    v_mul_f32 v135, v135, v103
    v_mul_f32 v134, v134, v102
    v_cvt_pk_bf16_f32 v126, v135, v134
    v_lshlrev_b32 v132, 16, v76
    v_and_b32 v133, 0xffff0000, v76
    v_mul_f32 v133, v133, v105
    v_mul_f32 v132, v132, v104
    v_cvt_pk_bf16_f32 v125, v133, v132
    v_lshlrev_b32 v134, 16, v77
    v_and_b32 v135, 0xffff0000, v77
    v_mul_f32 v135, v135, v107
    v_mul_f32 v134, v134, v106
    v_cvt_pk_bf16_f32 v124, v135, v134
    s_waitcnt lgkmcnt(0)
    v_dot2_f32_bf16 v100, v52, v98, 0
    v_dot2_f32_bf16 v101, v53, v95, 0
    v_dot2_f32_bf16 v102, v53, v98, 0
    v_dot2_f32_bf16 v103, v54, v95, 0
    v_dot2_f32_bf16 v104, v54, v98, 0
    v_dot2_f32_bf16 v105, v55, v95, 0
    v_dot2_f32_bf16 v106, v55, v98, 0
    v_dot2_f32_bf16 v107, v56, v95, 0
    v_dot2_f32_bf16 v100, v53, v96, v100
    v_dot2_f32_bf16 v101, v54, v94, v101
    v_dot2_f32_bf16 v102, v54, v96, v102
    v_dot2_f32_bf16 v103, v55, v94, v103
    v_dot2_f32_bf16 v104, v55, v96, v104
    v_dot2_f32_bf16 v105, v56, v94, v105
    v_dot2_f32_bf16 v106, v56, v96, v106
    v_dot2_f32_bf16 v107, v57, v94, v107
    v_dot2_f32_bf16 v100, v54, v97, v100
    v_dot2_f32_bf16 v102, v55, v97, v102
    v_dot2_f32_bf16 v104, v56, v97, v104
    v_dot2_f32_bf16 v106, v57, v97, v106
    v_lshlrev_b32 v132, 16, v78
    v_and_b32 v133, 0xffff0000, v78
    v_mul_f32 v133, v133, v101
    v_mul_f32 v132, v132, v100
    v_cvt_pk_bf16_f32 v131, v133, v132
    v_lshlrev_b32 v134, 16, v79
    v_and_b32 v135, 0xffff0000, v79
    v_mul_f32 v135, v135, v103
    v_mul_f32 v134, v134, v102
    v_cvt_pk_bf16_f32 v130, v135, v134
    v_lshlrev_b32 v132, 16, v80
    v_and_b32 v133, 0xffff0000, v80
    v_mul_f32 v133, v133, v105
    v_mul_f32 v132, v132, v104
    v_cvt_pk_bf16_f32 v129, v133, v132
    v_lshlrev_b32 v134, 16, v81
    v_and_b32 v135, 0xffff0000, v81
    v_mul_f32 v135, v135, v107
    v_mul_f32 v134, v134, v106
    v_cvt_pk_bf16_f32 v128, v135, v134
    v_mov_b32 v132, v124
    v_mov_b32 v133, v125
    v_mov_b32 v134, v126
    v_mov_b32 v135, v127
    v_mov_b32_dpp v127, v131 row_ror:8 row_mask:0xf bank_mask:0xc
    v_mov_b32_dpp v126, v130 row_ror:8 row_mask:0xf bank_mask:0xc
    v_mov_b32_dpp v125, v129 row_ror:8 row_mask:0xf bank_mask:0xc
    v_mov_b32_dpp v124, v128 row_ror:8 row_mask:0xf bank_mask:0xc
    v_mov_b32_dpp v128, v132 row_ror:8 row_mask:0xf bank_mask:0x3
    v_mov_b32_dpp v129, v133 row_ror:8 row_mask:0xf bank_mask:0x3
    v_mov_b32_dpp v130, v134 row_ror:8 row_mask:0xf bank_mask:0x3
    v_mov_b32_dpp v131, v135 row_ror:8 row_mask:0xf bank_mask:0x3
    buffer_store_dwordx4 v[124:127], v14, s[40:43], s66 offen sc1
    s_add_u32 s64, s66, 32768
    buffer_store_dwordx4 v[128:131], v14, s[40:43], s64 offen sc1
    s_add_u32 s66, s66, 524288
a1_done_26:
    s_waitcnt lgkmcnt(0)
    s_waitcnt vmcnt(0)
    v_cmp_ne_u32 vcc, 1, v136
    s_nop 1
    s_cmp_eq_u64 vcc, 0
    s_cbranch_scc1 a1_nz_27
    s_mov_b32 s44, s28
    s_mov_b32 s45, s29
    s_mov_b32 s46, 256
    s_mov_b32 s47, 0x20000
    v_and_b32 v2, 7, v1
    v_lshlrev_b32 v2, 2, v2
    s_mov_b32 s74, 400000
poll_28:
    buffer_load_dword v3, v2, s[44:47], 0 offen sc1
    s_waitcnt vmcnt(0)
    v_cmp_ne_u32 vcc, 1, v3
    s_sub_u32 s74, s74, 1
    s_cbranch_scc1 polld_29
    s_cmp_eq_u64 vcc, 0
    s_cbranch_scc1 polld_29
    s_sleep 1
    s_branch poll_28
polld_29:
a1_nz_27:
    s_barrier
    s_cmp_lg_u32 s3, 0
    s_cbranch_scc1 nofl_30
    s_lshl_b32 s74, s57, 7
    v_mov_b32 v2, 0
    v_mov_b32 v3, 1
    s_mov_b64 exec, 1
    buffer_store_dword v3, v2, s[48:51], s74 offen sc1
    s_mov_b64 exec, -1
nofl_30:
L_CONV:
    s_mov_b32 s32, s30
    s_mov_b32 s33, s31
    s_mov_b32 s34, 2621440
    s_mov_b32 s35, 0x20000
    s_mov_b32 s36, s8
    s_mov_b32 s37, s9
    s_mov_b32 s38, 2621440
    s_mov_b32 s39, 0x20000
    s_mov_b32 s40, s26
    s_mov_b32 s41, s27
    s_mov_b32 s42, 5242880
    s_mov_b32 s43, 0x20000
    v_and_b32 v2, 15, v1
    v_lshrrev_b32 v3, 4, v1
    v_mul_u32_u24 v9, 1280, v1
    s_mul_i32 s67, s3, 163840
    s_lshl_b32 s64, s67, 1
    s_lshl_b32 s63, s55, 1
    s_add_u32 s67, s67, s63
    s_add_u32 s64, s64, s63
    v_lshlrev_b32 v11, 1, v9
    v_lshrrev_b32 v12, 2, v2
    v_mul_u32_u24 v12, 2112, v12
    v_and_b32 v5, 3, v2
    v_lshl_add_u32 v12, v5, 3, v12
    v_lshl_add_u32 v12, v3, 5, v12
    s_lshl_b32 s63, s3, 8
    s_add_u32 s63, s63, 103936
    v_add_u32 v12, s63, v12
    s_add_u32 s60, s55, s3
    s_lshl_b32 s62, s60, 12
    v_lshlrev_b32 v4, 4, v1
    s_mov_b32 s44, s16
    s_mov_b32 s45, s17
    s_mov_b32 s46, 2621440
    s_mov_b32 s47, 0x20000
    buffer_load_dwordx4 v[44:47], v4, s[44:47], s62 offen offset:0
    buffer_load_dwordx4 v[48:51], v4, s[44:47], s62 offen offset:1024
    buffer_load_dwordx4 v[52:55], v4, s[44:47], s62 offen offset:2048
    buffer_load_dwordx4 v[56:59], v4, s[44:47], s62 offen offset:3072
nh1_33:
    s_mul_i32 s61, s3, 4672
    s_add_u32 s61, s61, 66560
    s_mul_i32 s66, s3, 8320
    s_cmp_ge_u32 s60, 320
    s_cselect_b32 s63, 32, 0
    v_and_b32 v10, 31, v1
    v_add_u32 v10, s63, v10
    v_lshlrev_b32 v10, 7, v10
    v_mov_b32 v20, 0
    v_mov_b32 v21, 0
    v_mov_b32 v22, 0
    v_mov_b32 v23, 0
    v_and_b32 v5, 1, v2
    v_cmp_eq_u32 vcc, 1, v5
    v_mov_b32 v5, 4160
    v_mov_b32 v6, 2
    v_cndmask_b32 v5, v5, v6, vcc
    v_lshl_add_u32 v5, v2, 1, v5
    v_lshl_add_u32 v5, v3, 4, v5
    v_add_u32 v13, s66, v5
    v_add_u32 v14, 1024, v13
    v_add_u32 v15, 2048, v13
    v_add_u32 v16, 3072, v13
    v_lshlrev_b32 v4, 4, v1
    v_add_u32 v8, s61, v4
    s_and_b32 s63, s60, 1
    s_lshl_b32 s63, s63, 4
    s_lshr_b32 s65, s5, s63
    s_and_b32 s65, s65, 0xffff
    v_lshl_add_u32 v5, v3, 3, v2
    v_sub_u32 v5, 15, v5
    v_and_b32 v6, 1, v5
    v_lshlrev_b32 v6, 4, v6
    v_lshlrev_b32 v6, v6, s65
    v_ashrrev_i32 v5, 1, v5
    v_cmp_eq_u32 vcc, 0, v5
    s_nop 1
    v_cndmask_b32 v24, 0, v6, vcc
    v_cmp_eq_u32 vcc, 1, v5
    s_nop 1
    v_cndmask_b32 v25, 0, v6, vcc
    v_cmp_eq_u32 vcc, 2, v5
    s_nop 1
    v_cndmask_b32 v26, 0, v6, vcc
    v_cmp_eq_u32 vcc, 3, v5
    s_nop 1
    v_cndmask_b32 v27, 0, v6, vcc
    v_lshlrev_b32 v5, 5, v2
    v_sub_u32 v7, 480, v5
    v_lshl_add_u32 v7, v3, 4, v7
    v_add_u32 v7, s61, v7
    s_waitcnt vmcnt(0)
    s_mul_i32 s63, s3, 8320
    v_add_u32 v5, s63, v4
    v_readfirstlane_b32 s63, v44
    ds_write_b128 v5, v[44:47] offset:32
    ds_write_b128 v5, v[48:51] offset:1056
    ds_write_b128 v5, v[52:55] offset:2080
    ds_write_b128 v5, v[56:59] offset:3104
    v_mov_b32_dpp v111, v48 wave_rol:1 row_mask:0xf bank_mask:0xf
    v_mov_b32_dpp v115, v52 wave_rol:1 row_mask:0xf bank_mask:0xf
    v_mov_b32_dpp v119, v56 wave_rol:1 row_mask:0xf bank_mask:0xf
    v_mov_b32_dpp v123, v44 wave_rol:1 row_mask:0xf bank_mask:0xf
    v_mov_b32_dpp v111, v44 wave_shl:1 row_mask:0xf bank_mask:0xf
    v_mov_b32_dpp v115, v48 wave_shl:1 row_mask:0xf bank_mask:0xf
    v_mov_b32_dpp v119, v52 wave_shl:1 row_mask:0xf bank_mask:0xf
    v_mov_b32_dpp v123, v56 wave_shl:1 row_mask:0xf bank_mask:0xf
    v_mov_b32 v124, 0
    v_mov_b32 v125, 0
    v_mov_b32 v126, 0
    v_mov_b32 v127, 0
    s_lshl_b32 s63, s63, 16
    s_mov_b64 exec, 3
    ds_write_b128 v5, v[124:127] offset:0
    s_mov_b64 exec, -1
    v_alignbit_b32 v108, v45, v44, 16
    v_alignbit_b32 v109, v46, v45, 16
    v_alignbit_b32 v110, v47, v46, 16
    v_alignbit_b32 v111, v111, v47, 16
    ds_write_b128 v5, v[108:111] offset:4192
    v_alignbit_b32 v112, v49, v48, 16
    v_alignbit_b32 v113, v50, v49, 16
    v_alignbit_b32 v114, v51, v50, 16
    v_alignbit_b32 v115, v115, v51, 16
    ds_write_b128 v5, v[112:115] offset:5216
    v_alignbit_b32 v116, v53, v52, 16
    v_alignbit_b32 v117, v54, v53, 16
    v_alignbit_b32 v118, v55, v54, 16
    v_alignbit_b32 v119, v119, v55, 16
    ds_write_b128 v5, v[116:119] offset:6240
    v_alignbit_b32 v120, v57, v56, 16
    v_alignbit_b32 v121, v58, v57, 16
    v_alignbit_b32 v122, v59, v58, 16
    v_alignbit_b32 v123, v123, v59, 16
    ds_write_b128 v5, v[120:123] offset:7264
    v_writelane_b32 v127, s63, 1
    s_mov_b64 exec, 3
    ds_write_b128 v5, v[124:127] offset:4160
    s_mov_b64 exec, -1
nh2_34:
    s_mov_b32 exec_hi, 0
    ds_write_b128 v8, v[20:23] offset:4096
    s_mov_b64 exec, -1
    s_waitcnt lgkmcnt(0)
    ds_read2_b32 v[44:45], v13 offset0:0 offset1:1
    ds_read2_b32 v[46:47], v13 offset0:2 offset1:3
    ds_read2_b32 v[48:49], v13 offset0:128 offset1:129
    ds_read2_b32 v[50:51], v13 offset0:130 offset1:131
    ds_read2_b32 v[52:53], v14 offset0:0 offset1:1
    ds_read2_b32 v[54:55], v14 offset0:2 offset1:3
    ds_read2_b32 v[56:57], v14 offset0:128 offset1:129
    ds_read2_b32 v[58:59], v14 offset0:130 offset1:131
    ds_read2_b32 v[60:61], v15 offset0:0 offset1:1
    ds_read2_b32 v[62:63], v15 offset0:2 offset1:3
    ds_read2_b32 v[64:65], v15 offset0:128 offset1:129
    ds_read2_b32 v[66:67], v15 offset0:130 offset1:131
    ds_read2_b32 v[68:69], v16 offset0:0 offset1:1
    ds_read2_b32 v[70:71], v16 offset0:2 offset1:3
    ds_read2_b32 v[72:73], v16 offset0:128 offset1:129
    ds_read2_b32 v[74:75], v16 offset0:130 offset1:131
    s_cmp_lg_u32 s3, 1
    s_cbranch_scc1 nopoll_35
    s_mov_b32 s74, 400000
poll_36:
    buffer_load_dword v5, v10, s[48:51], 0 offen sc1
    s_waitcnt vmcnt(0)
    v_cmp_ne_u32 vcc, 1, v5
    s_sub_u32 s74, s74, 1
    s_cbranch_scc1 polld_37
    s_cmp_eq_u64 vcc, 0
    s_cbranch_scc1 polld_37
    s_sleep 2
    s_branch poll_36
polld_37:
nopoll_35:
    s_barrier
    buffer_load_dwordx4 v[76:79], v4, s[32:35], s62 offen offset:0 sc1
    buffer_load_dwordx4 v[80:83], v4, s[32:35], s62 offen offset:1024 sc1
    buffer_load_dwordx4 v[84:87], v4, s[32:35], s62 offen offset:2048 sc1
    buffer_load_dwordx4 v[88:91], v4, s[32:35], s62 offen offset:3072 sc1
    s_waitcnt vmcnt(3)
    ds_write_b128 v8, v[76:79] offset:0
    s_waitcnt vmcnt(2)
    ds_write_b128 v8, v[80:83] offset:1024
    s_waitcnt vmcnt(1)
    ds_write_b128 v8, v[84:87] offset:2048
    s_waitcnt vmcnt(0)
    ds_write_b128 v8, v[88:91] offset:3072
    v_lshlrev_b32 v5, 5, v2
    v_lshl_add_u32 v8, v3, 3, v5
    s_mul_i32 s63, s3, 2112
    s_add_u32 s63, s63, 103936
    v_add_u32 v8, s63, v8
    s_cmp_eq_u32 s56, 0
    s_cbranch_scc1 nqt_38
    s_barrier
    s_lshl_b32 s68, s3, 3
    s_add_u32 s68, s68, s59
    s_sub_u32 s68, s68, 16
    s_cmp_lt_u32 s68, 32
    s_cbranch_scc1 pq2_40
    s_xor_b32 s69, s68, 48
    s_mul_i32 s69, s69, 81920
    s_lshl_b32 s70, s58, 7
    s_add_u32 s69, s69, s70
    buffer_load_dword v250, v9, s[36:39], s69 offen
    s_branch pnq_39
pq2_40:
    s_and_b32 s69, s58, 1
    s_cbranch_scc1 pnq_39
    s_cmp_lt_u32 s68, 16
    s_cbranch_scc1 pnq_39
    s_and_b32 s70, s56, 2
    s_lshl_b32 s70, s70, 3
    s_xor_b32 s69, s68, s70
    s_mul_i32 s69, s69, 81920
    s_lshl_b32 s70, s55, 1
    s_add_u32 s69, s69, s70
    buffer_load_dword v250, v9, s[36:39], s69 offen
pnq_39:
nqt_38:
    s_cmp_eq_u32 s56, 2
    s_cbranch_scc1 lo4_41
    ds_read_b128 v[108:111], v7 offset:3584
    ds_read_b128 v[112:115], v7 offset:3072
    ds_read_b128 v[116:119], v7 offset:2560
    ds_read_b128 v[120:123], v7 offset:2048
    ds_read_b128 v[124:127], v7 offset:1536
    ds_read_b128 v[128:131], v7 offset:1024
    ds_read_b128 v[132:135], v7 offset:512
    ds_read_b128 v[136:139], v7 offset:0
    s_waitcnt lgkmcnt(0)
    s_setprio 3
    v_mfma_f32_16x16x32_bf16 v[172:175], v[24:27], v[108:111], 0
    ds_read_b128 v[140:143], v7 offset:3648
    v_mfma_f32_16x16x32_bf16 v[176:179], v[24:27], v[112:115], 0
    ds_read2_b32 v[76:77], v13 offset0:16 offset1:17
    v_mfma_f32_16x16x32_bf16 v[180:183], v[24:27], v[116:119], 0
    ds_read2_b32 v[78:79], v13 offset0:18 offset1:19
    v_mfma_f32_16x16x32_bf16 v[184:187], v[24:27], v[120:123], 0
    ds_read_b128 v[144:147], v7 offset:3136
    v_mfma_f32_16x16x32_bf16 v[188:191], v[24:27], v[124:127], 0
    ds_read2_b32 v[80:81], v13 offset0:144 offset1:145
    v_mfma_f32_16x16x32_bf16 v[192:195], v[24:27], v[128:131], 0
    ds_read2_b32 v[82:83], v13 offset0:146 offset1:147
    v_mfma_f32_16x16x32_bf16 v[196:199], v[24:27], v[132:135], 0
    ds_read_b128 v[148:151], v7 offset:2624
    v_mfma_f32_16x16x32_bf16 v[200:203], v[24:27], v[136:139], 0
    ds_read2_b32 v[84:85], v14 offset0:16 offset1:17
    v_mfma_f32_16x16x32_bf16 v[188:191], v[44:47], v[124:127], v[188:191]
    ds_read2_b32 v[86:87], v14 offset0:18 offset1:19
    v_mfma_f32_16x16x32_bf16 v[192:195], v[44:47], v[128:131], v[192:195]
    ds_read_b128 v[152:155], v7 offset:2112
    v_mfma_f32_16x16x32_bf16 v[196:199], v[44:47], v[132:135], v[196:199]
    ds_read2_b32 v[88:89], v14 offset0:144 offset1:145
    v_mfma_f32_16x16x32_bf16 v[200:203], v[44:47], v[136:139], v[200:203]
    ds_read2_b32 v[90:91], v14 offset0:146 offset1:147
    v_mfma_f32_16x16x32_bf16 v[188:191], v[48:51], v[120:123], v[188:191]
    ds_read_b128 v[156:159], v7 offset:1600
    v_mfma_f32_16x16x32_bf16 v[192:195], v[48:51], v[124:127], v[192:195]
    ds_read2_b32 v[92:93], v15 offset0:16 offset1:17
    v_mfma_f32_16x16x32_bf16 v[196:199], v[48:51], v[128:131], v[196:199]
    ds_read2_b32 v[94:95], v15 offset0:18 offset1:19
    v_mfma_f32_16x16x32_bf16 v[200:203], v[48:51], v[132:135], v[200:203]
    ds_read_b128 v[160:163], v7 offset:1088
    v_mfma_f32_16x16x32_bf16 v[188:191], v[52:55], v[116:119], v[188:191]
    ds_read2_b32 v[96:97], v15 offset0:144 offset1:145
    v_mfma_f32_16x16x32_bf16 v[192:195], v[52:55], v[120:123], v[192:195]
    ds_read2_b32 v[98:99], v15 offset0:146 offset1:147
    v_mfma_f32_16x16x32_bf16 v[196:199], v[52:55], v[124:127], v[196:199]
    ds_read_b128 v[164:167], v7 offset:576
    v_mfma_f32_16x16x32_bf16 v[200:203], v[52:55], v[128:131], v[200:203]
    ds_read2_b32 v[100:101], v16 offset0:16 offset1:17
    v_mfma_f32_16x16x32_bf16 v[188:191], v[56:59], v[112:115], v[188:191]
    ds_read2_b32 v[102:103], v16 offset0:18 offset1:19
    v_mfma_f32_16x16x32_bf16 v[192:195], v[56:59], v[116:119], v[192:195]
    ds_read_b128 v[168:171], v7 offset:64
    v_mfma_f32_16x16x32_bf16 v[196:199], v[56:59], v[120:123], v[196:199]
    ds_read2_b32 v[104:105], v16 offset0:144 offset1:145
    v_mfma_f32_16x16x32_bf16 v[200:203], v[56:59], v[124:127], v[200:203]
    ds_read2_b32 v[106:107], v16 offset0:146 offset1:147
    v_mfma_f32_16x16x32_bf16 v[188:191], v[60:63], v[108:111], v[188:191]
    v_mfma_f32_16x16x32_bf16 v[192:195], v[60:63], v[112:115], v[192:195]
    v_mfma_f32_16x16x32_bf16 v[196:199], v[60:63], v[116:119], v[196:199]
    v_mfma_f32_16x16x32_bf16 v[200:203], v[60:63], v[120:123], v[200:203]
    v_mfma_f32_16x16x32_bf16 v[192:195], v[64:67], v[108:111], v[192:195]
    v_mfma_f32_16x16x32_bf16 v[196:199], v[64:67], v[112:115], v[196:199]
    v_mfma_f32_16x16x32_bf16 v[200:203], v[64:67], v[116:119], v[200:203]
    v_mfma_f32_16x16x32_bf16 v[196:199], v[68:71], v[108:111], v[196:199]
    v_mfma_f32_16x16x32_bf16 v[200:203], v[68:71], v[112:115], v[200:203]
    v_mfma_f32_16x16x32_bf16 v[200:203], v[72:75], v[108:111], v[200:203]
    s_waitcnt lgkmcnt(0)
    s_setprio 3
    v_mfma_f32_16x16x32_bf16 v[188:191], v[76:79], v[156:159], v[188:191]
    ds_read_b128 v[108:111], v7 offset:3712
    v_mfma_f32_16x16x32_bf16 v[192:195], v[76:79], v[160:163], v[192:195]
    ds_read2_b32 v[44:45], v13 offset0:32 offset1:33
    v_mfma_f32_16x16x32_bf16 v[196:199], v[76:79], v[164:167], v[196:199]
    ds_read2_b32 v[46:47], v13 offset0:34 offset1:35
    v_mfma_f32_16x16x32_bf16 v[200:203], v[76:79], v[168:171], v[200:203]
    ds_read_b128 v[112:115], v7 offset:3200
    v_mfma_f32_16x16x32_bf16 v[188:191], v[80:83], v[152:155], v[188:191]
    ds_read2_b32 v[48:49], v13 offset0:160 offset1:161
    v_mfma_f32_16x16x32_bf16 v[192:195], v[80:83], v[156:159], v[192:195]
    ds_read2_b32 v[50:51], v13 offset0:162 offset1:163
    v_mfma_f32_16x16x32_bf16 v[196:199], v[80:83], v[160:163], v[196:199]
    ds_read_b128 v[116:119], v7 offset:2688
    v_mfma_f32_16x16x32_bf16 v[200:203], v[80:83], v[164:167], v[200:203]
    ds_read2_b32 v[52:53], v14 offset0:32 offset1:33
    v_mfma_f32_16x16x32_bf16 v[188:191], v[84:87], v[148:151], v[188:191]
    ds_read2_b32 v[54:55], v14 offset0:34 offset1:35
    v_mfma_f32_16x16x32_bf16 v[192:195], v[84:87], v[152:155], v[192:195]
    ds_read_b128 v[120:123], v7 offset:2176
    v_mfma_f32_16x16x32_bf16 v[196:199], v[84:87], v[156:159], v[196:199]
    ds_read2_b32 v[56:57], v14 offset0:160 offset1:161
    v_mfma_f32_16x16x32_bf16 v[200:203], v[84:87], v[160:163], v[200:203]
    ds_read2_b32 v[58:59], v14 offset0:162 offset1:163
    v_mfma_f32_16x16x32_bf16 v[188:191], v[88:91], v[144:147], v[188:191]
    ds_read_b128 v[124:127], v7 offset:1664
    v_mfma_f32_16x16x32_bf16 v[192:195], v[88:91], v[148:151], v[192:195]
    ds_read2_b32 v[60:61], v15 offset0:32 offset1:33
    v_mfma_f32_16x16x32_bf16 v[196:199], v[88:91], v[152:155], v[196:199]
    ds_read2_b32 v[62:63], v15 offset0:34 offset1:35
    v_mfma_f32_16x16x32_bf16 v[200:203], v[88:91], v[156:159], v[200:203]
    ds_read_b128 v[128:131], v7 offset:1152
    v_mfma_f32_16x16x32_bf16 v[188:191], v[92:95], v[140:143], v[188:191]
    ds_read2_b32 v[64:65], v15 offset0:160 offset1:161
    v_mfma_f32_16x16x32_bf16 v[192:195], v[92:95], v[144:147], v[192:195]
    ds_read2_b32 v[66:67], v15 offset0:162 offset1:163
    v_mfma_f32_16x16x32_bf16 v[196:199], v[92:95], v[148:151], v[196:199]
    ds_read_b128 v[132:135], v7 offset:640
    v_mfma_f32_16x16x32_bf16 v[200:203], v[92:95], v[152:155], v[200:203]
    ds_read2_b32 v[68:69], v16 offset0:32 offset1:33
    v_mfma_f32_16x16x32_bf16 v[192:195], v[96:99], v[140:143], v[192:195]
    ds_read2_b32 v[70:71], v16 offset0:34 offset1:35
    v_mfma_f32_16x16x32_bf16 v[196:199], v[96:99], v[144:147], v[196:199]
    ds_read_b128 v[136:139], v7 offset:128
    v_mfma_f32_16x16x32_bf16 v[200:203], v[96:99], v[148:151], v[200:203]
    ds_read2_b32 v[72:73], v16 offset0:160 offset1:161
    v_mfma_f32_16x16x32_bf16 v[196:199], v[100:103], v[140:143], v[196:199]
    ds_read2_b32 v[74:75], v16 offset0:162 offset1:163
    v_mfma_f32_16x16x32_bf16 v[200:203], v[100:103], v[144:147], v[200:203]
    v_mfma_f32_16x16x32_bf16 v[200:203], v[104:107], v[140:143], v[200:203]
    s_waitcnt lgkmcnt(0)
    s_setprio 2
    v_mfma_f32_16x16x32_bf16 v[188:191], v[44:47], v[124:127], v[188:191]
    ds_read_b128 v[140:143], v7 offset:3776
    v_mfma_f32_16x16x32_bf16 v[192:195], v[44:47], v[128:131], v[192:195]
    ds_read2_b32 v[76:77], v13 offset0:48 offset1:49
    v_mfma_f32_16x16x32_bf16 v[196:199], v[44:47], v[132:135], v[196:199]
    ds_read2_b32 v[78:79], v13 offset0:50 offset1:51
    v_mfma_f32_16x16x32_bf16 v[200:203], v[44:47], v[136:139], v[200:203]
    ds_read_b128 v[144:147], v7 offset:3264
    v_mfma_f32_16x16x32_bf16 v[188:191], v[48:51], v[120:123], v[188:191]
    ds_read2_b32 v[80:81], v13 offset0:176 offset1:177
    v_mfma_f32_16x16x32_bf16 v[192:195], v[48:51], v[124:127], v[192:195]
    ds_read2_b32 v[82:83], v13 offset0:178 offset1:179
    v_mfma_f32_16x16x32_bf16 v[196:199], v[48:51], v[128:131], v[196:199]
    ds_read_b128 v[148:151], v7 offset:2752
    v_mfma_f32_16x16x32_bf16 v[200:203], v[48:51], v[132:135], v[200:203]
    ds_read2_b32 v[84:85], v14 offset0:48 offset1:49
    v_mfma_f32_16x16x32_bf16 v[188:191], v[52:55], v[116:119], v[188:191]
    ds_read2_b32 v[86:87], v14 offset0:50 offset1:51
    v_mfma_f32_16x16x32_bf16 v[192:195], v[52:55], v[120:123], v[192:195]
    ds_read_b128 v[152:155], v7 offset:2240
    v_mfma_f32_16x16x32_bf16 v[196:199], v[52:55], v[124:127], v[196:199]
    ds_read2_b32 v[88:89], v14 offset0:176 offset1:177
    v_mfma_f32_16x16x32_bf16 v[200:203], v[52:55], v[128:131], v[200:203]
    ds_read2_b32 v[90:91], v14 offset0:178 offset1:179
    v_mfma_f32_16x16x32_bf16 v[188:191], v[56:59], v[112:115], v[188:191]
    ds_read_b128 v[156:159], v7 offset:1728
    v_mfma_f32_16x16x32_bf16 v[192:195], v[56:59], v[116:119], v[192:195]
    ds_read2_b32 v[92:93], v15 offset0:48 offset1:49
    v_mfma_f32_16x16x32_bf16 v[196:199], v[56:59], v[120:123], v[196:199]
    ds_read2_b32 v[94:95], v15 offset0:50 offset1:51
    v_mfma_f32_16x16x32_bf16 v[200:203], v[56:59], v[124:127], v[200:203]
    ds_read_b128 v[160:163], v7 offset:1216
    v_mfma_f32_16x16x32_bf16 v[188:191], v[60:63], v[108:111], v[188:191]
    ds_read2_b32 v[96:97], v15 offset0:176 offset1:177
    v_mfma_f32_16x16x32_bf16 v[192:195], v[60:63], v[112:115], v[192:195]
    ds_read2_b32 v[98:99], v15 offset0:178 offset1:179
    v_mfma_f32_16x16x32_bf16 v[196:199], v[60:63], v[116:119], v[196:199]
    ds_read_b128 v[164:167], v7 offset:704
    v_mfma_f32_16x16x32_bf16 v[200:203], v[60:63], v[120:123], v[200:203]
    ds_read2_b32 v[100:101], v16 offset0:48 offset1:49
    v_mfma_f32_16x16x32_bf16 v[192:195], v[64:67], v[108:111], v[192:195]
    ds_read2_b32 v[102:103], v16 offset0:50 offset1:51
    v_mfma_f32_16x16x32_bf16 v[196:199], v[64:67], v[112:115], v[196:199]
    ds_read_b128 v[168:171], v7 offset:192
    v_mfma_f32_16x16x32_bf16 v[200:203], v[64:67], v[116:119], v[200:203]
    ds_read2_b32 v[104:105], v16 offset0:176 offset1:177
    v_mfma_f32_16x16x32_bf16 v[196:199], v[68:71], v[108:111], v[196:199]
    ds_read2_b32 v[106:107], v16 offset0:178 offset1:179
    v_mfma_f32_16x16x32_bf16 v[200:203], v[68:71], v[112:115], v[200:203]
    v_mfma_f32_16x16x32_bf16 v[200:203], v[72:75], v[108:111], v[200:203]
    s_waitcnt lgkmcnt(0)
    s_setprio 2
    s_add_u32 s63, s67, 1310720
    buffer_load_dwordx4 v[28:31], v9, s[36:39], s63 offen
qs_43:
    v_mfma_f32_16x16x32_bf16 v[188:191], v[76:79], v[156:159], v[188:191]
    ds_read_b128 v[108:111], v7 offset:3840
    v_mfma_f32_16x16x32_bf16 v[192:195], v[76:79], v[160:163], v[192:195]
    ds_read2_b32 v[44:45], v13 offset0:64 offset1:65
    v_mfma_f32_16x16x32_bf16 v[196:199], v[76:79], v[164:167], v[196:199]
    ds_read2_b32 v[46:47], v13 offset0:66 offset1:67
    v_mfma_f32_16x16x32_bf16 v[200:203], v[76:79], v[168:171], v[200:203]
    ds_read_b128 v[112:115], v7 offset:3328
    v_mfma_f32_16x16x32_bf16 v[188:191], v[80:83], v[152:155], v[188:191]
    ds_read2_b32 v[48:49], v13 offset0:192 offset1:193
    v_mfma_f32_16x16x32_bf16 v[192:195], v[80:83], v[156:159], v[192:195]
    ds_read2_b32 v[50:51], v13 offset0:194 offset1:195
    v_mfma_f32_16x16x32_bf16 v[196:199], v[80:83], v[160:163], v[196:199]
    ds_read_b128 v[116:119], v7 offset:2816
    v_mfma_f32_16x16x32_bf16 v[200:203], v[80:83], v[164:167], v[200:203]
    ds_read2_b32 v[52:53], v14 offset0:64 offset1:65
    v_mfma_f32_16x16x32_bf16 v[188:191], v[84:87], v[148:151], v[188:191]
    ds_read2_b32 v[54:55], v14 offset0:66 offset1:67
    v_mfma_f32_16x16x32_bf16 v[192:195], v[84:87], v[152:155], v[192:195]
    ds_read_b128 v[120:123], v7 offset:2304
    v_mfma_f32_16x16x32_bf16 v[196:199], v[84:87], v[156:159], v[196:199]
    ds_read2_b32 v[56:57], v14 offset0:192 offset1:193
    v_mfma_f32_16x16x32_bf16 v[200:203], v[84:87], v[160:163], v[200:203]
    ds_read2_b32 v[58:59], v14 offset0:194 offset1:195
    v_mfma_f32_16x16x32_bf16 v[188:191], v[88:91], v[144:147], v[188:191]
    ds_read_b128 v[124:127], v7 offset:1792
    v_mfma_f32_16x16x32_bf16 v[192:195], v[88:91], v[148:151], v[192:195]
    ds_read2_b32 v[60:61], v15 offset0:64 offset1:65
    v_mfma_f32_16x16x32_bf16 v[196:199], v[88:91], v[152:155], v[196:199]
    ds_read2_b32 v[62:63], v15 offset0:66 offset1:67
    v_mfma_f32_16x16x32_bf16 v[200:203], v[88:91], v[156:159], v[200:203]
    ds_read_b128 v[128:131], v7 offset:1280
    v_mfma_f32_16x16x32_bf16 v[188:191], v[92:95], v[140:143], v[188:191]
    ds_read2_b32 v[64:65], v15 offset0:192 offset1:193
    v_mfma_f32_16x16x32_bf16 v[192:195], v[92:95], v[144:147], v[192:195]
    ds_read2_b32 v[66:67], v15 offset0:194 offset1:195
    v_mfma_f32_16x16x32_bf16 v[196:199], v[92:95], v[148:151], v[196:199]
    ds_read_b128 v[132:135], v7 offset:768
    v_mfma_f32_16x16x32_bf16 v[200:203], v[92:95], v[152:155], v[200:203]
    ds_read2_b32 v[68:69], v16 offset0:64 offset1:65
    v_mfma_f32_16x16x32_bf16 v[192:195], v[96:99], v[140:143], v[192:195]
    ds_read2_b32 v[70:71], v16 offset0:66 offset1:67
    v_mfma_f32_16x16x32_bf16 v[196:199], v[96:99], v[144:147], v[196:199]
    ds_read_b128 v[136:139], v7 offset:256
    v_mfma_f32_16x16x32_bf16 v[200:203], v[96:99], v[148:151], v[200:203]
    ds_read2_b32 v[72:73], v16 offset0:192 offset1:193
    v_mfma_f32_16x16x32_bf16 v[196:199], v[100:103], v[140:143], v[196:199]
    ds_read2_b32 v[74:75], v16 offset0:194 offset1:195
    v_mfma_f32_16x16x32_bf16 v[200:203], v[100:103], v[144:147], v[200:203]
    v_mfma_f32_16x16x32_bf16 v[200:203], v[104:107], v[140:143], v[200:203]
    s_waitcnt lgkmcnt(0)
    s_setprio 1
    s_add_u32 s63, s67, 1392640
    buffer_load_dwordx4 v[32:35], v9, s[36:39], s63 offen
qs_44:
    v_mfma_f32_16x16x32_bf16 v[188:191], v[44:47], v[124:127], v[188:191]
    ds_read_b128 v[140:143], v7 offset:3904
    v_mfma_f32_16x16x32_bf16 v[192:195], v[44:47], v[128:131], v[192:195]
    ds_read2_b32 v[76:77], v13 offset0:80 offset1:81
    v_mfma_f32_16x16x32_bf16 v[196:199], v[44:47], v[132:135], v[196:199]
    ds_read2_b32 v[78:79], v13 offset0:82 offset1:83
    v_mfma_f32_16x16x32_bf16 v[200:203], v[44:47], v[136:139], v[200:203]
    ds_read_b128 v[144:147], v7 offset:3392
    v_mfma_f32_16x16x32_bf16 v[188:191], v[48:51], v[120:123], v[188:191]
    ds_read2_b32 v[80:81], v13 offset0:208 offset1:209
    v_mfma_f32_16x16x32_bf16 v[192:195], v[48:51], v[124:127], v[192:195]
    ds_read2_b32 v[82:83], v13 offset0:210 offset1:211
    v_mfma_f32_16x16x32_bf16 v[196:199], v[48:51], v[128:131], v[196:199]
    ds_read_b128 v[148:151], v7 offset:2880
    v_mfma_f32_16x16x32_bf16 v[200:203], v[48:51], v[132:135], v[200:203]
    ds_read2_b32 v[84:85], v14 offset0:80 offset1:81
    v_mfma_f32_16x16x32_bf16 v[188:191], v[52:55], v[116:119], v[188:191]
    ds_read2_b32 v[86:87], v14 offset0:82 offset1:83
    v_mfma_f32_16x16x32_bf16 v[192:195], v[52:55], v[120:123], v[192:195]
    ds_read_b128 v[152:155], v7 offset:2368
    v_mfma_f32_16x16x32_bf16 v[196:199], v[52:55], v[124:127], v[196:199]
    ds_read2_b32 v[88:89], v14 offset0:208 offset1:209
    v_mfma_f32_16x16x32_bf16 v[200:203], v[52:55], v[128:131], v[200:203]
    ds_read2_b32 v[90:91], v14 offset0:210 offset1:211
    v_mfma_f32_16x16x32_bf16 v[188:191], v[56:59], v[112:115], v[188:191]
    ds_read_b128 v[156:159], v7 offset:1856
    v_mfma_f32_16x16x32_bf16 v[192:195], v[56:59], v[116:119], v[192:195]
    ds_read2_b32 v[92:93], v15 offset0:80 offset1:81
    v_mfma_f32_16x16x32_bf16 v[196:199], v[56:59], v[120:123], v[196:199]
    ds_read2_b32 v[94:95], v15 offset0:82 offset1:83
    v_mfma_f32_16x16x32_bf16 v[200:203], v[56:59], v[124:127], v[200:203]
    ds_read_b128 v[160:163], v7 offset:1344
    v_mfma_f32_16x16x32_bf16 v[188:191], v[60:63], v[108:111], v[188:191]
    ds_read2_b32 v[96:97], v15 offset0:208 offset1:209
    v_mfma_f32_16x16x32_bf16 v[192:195], v[60:63], v[112:115], v[192:195]
    ds_read2_b32 v[98:99], v15 offset0:210 offset1:211
    v_mfma_f32_16x16x32_bf16 v[196:199], v[60:63], v[116:119], v[196:199]
    ds_read_b128 v[164:167], v7 offset:832
    v_mfma_f32_16x16x32_bf16 v[200:203], v[60:63], v[120:123], v[200:203]
    ds_read2_b32 v[100:101], v16 offset0:80 offset1:81
    v_mfma_f32_16x16x32_bf16 v[192:195], v[64:67], v[108:111], v[192:195]
    ds_read2_b32 v[102:103], v16 offset0:82 offset1:83
    v_mfma_f32_16x16x32_bf16 v[196:199], v[64:67], v[112:115], v[196:199]
    ds_read_b128 v[168:171], v7 offset:320
    v_mfma_f32_16x16x32_bf16 v[200:203], v[64:67], v[116:119], v[200:203]
    ds_read2_b32 v[104:105], v16 offset0:208 offset1:209
    v_mfma_f32_16x16x32_bf16 v[196:199], v[68:71], v[108:111], v[196:199]
    ds_read2_b32 v[106:107], v16 offset0:210 offset1:211
    v_mfma_f32_16x16x32_bf16 v[200:203], v[68:71], v[112:115], v[200:203]
    v_mfma_f32_16x16x32_bf16 v[200:203], v[72:75], v[108:111], v[200:203]
    s_waitcnt lgkmcnt(0)
    s_setprio 1
    s_cmp_lg_u32 s56, 0
    s_cbranch_scc1 qs_45
    s_add_u32 s63, s67, 0
    buffer_load_dwordx4 v[36:39], v9, s[36:39], s63 offen
qs_45:
    v_mfma_f32_16x16x32_bf16 v[188:191], v[76:79], v[156:159], v[188:191]
    ds_read_b128 v[108:111], v7 offset:3968
    v_mfma_f32_16x16x32_bf16 v[192:195], v[76:79], v[160:163], v[192:195]
    ds_read2_b32 v[44:45], v13 offset0:96 offset1:97
    v_mfma_f32_16x16x32_bf16 v[196:199], v[76:79], v[164:167], v[196:199]
    ds_read2_b32 v[46:47], v13 offset0:98 offset1:99
    v_mfma_f32_16x16x32_bf16 v[200:203], v[76:79], v[168:171], v[200:203]
    ds_read_b128 v[112:115], v7 offset:3456
    v_mfma_f32_16x16x32_bf16 v[188:191], v[80:83], v[152:155], v[188:191]
    ds_read2_b32 v[48:49], v13 offset0:224 offset1:225
    v_mfma_f32_16x16x32_bf16 v[192:195], v[80:83], v[156:159], v[192:195]
    ds_read2_b32 v[50:51], v13 offset0:226 offset1:227
    v_mfma_f32_16x16x32_bf16 v[196:199], v[80:83], v[160:163], v[196:199]
    ds_read_b128 v[116:119], v7 offset:2944
    v_mfma_f32_16x16x32_bf16 v[200:203], v[80:83], v[164:167], v[200:203]
    ds_read2_b32 v[52:53], v14 offset0:96 offset1:97
    v_mfma_f32_16x16x32_bf16 v[188:191], v[84:87], v[148:151], v[188:191]
    ds_read2_b32 v[54:55], v14 offset0:98 offset1:99
    v_mfma_f32_16x16x32_bf16 v[192:195], v[84:87], v[152:155], v[192:195]
    ds_read_b128 v[120:123], v7 offset:2432
    v_mfma_f32_16x16x32_bf16 v[196:199], v[84:87], v[156:159], v[196:199]
    ds_read2_b32 v[56:57], v14 offset0:224 offset1:225
    v_mfma_f32_16x16x32_bf16 v[200:203], v[84:87], v[160:163], v[200:203]
    ds_read2_b32 v[58:59], v14 offset0:226 offset1:227
    v_mfma_f32_16x16x32_bf16 v[188:191], v[88:91], v[144:147], v[188:191]
    ds_read_b128 v[124:127], v7 offset:1920
    v_mfma_f32_16x16x32_bf16 v[192:195], v[88:91], v[148:151], v[192:195]
    ds_read2_b32 v[60:61], v15 offset0:96 offset1:97
    v_mfma_f32_16x16x32_bf16 v[196:199], v[88:91], v[152:155], v[196:199]
    ds_read2_b32 v[62:63], v15 offset0:98 offset1:99
    v_mfma_f32_16x16x32_bf16 v[200:203], v[88:91], v[156:159], v[200:203]
    ds_read_b128 v[128:131], v7 offset:1408
    v_mfma_f32_16x16x32_bf16 v[188:191], v[92:95], v[140:143], v[188:191]
    ds_read2_b32 v[64:65], v15 offset0:224 offset1:225
    v_mfma_f32_16x16x32_bf16 v[192:195], v[92:95], v[144:147], v[192:195]
    ds_read2_b32 v[66:67], v15 offset0:226 offset1:227
    v_mfma_f32_16x16x32_bf16 v[196:199], v[92:95], v[148:151], v[196:199]
    ds_read_b128 v[132:135], v7 offset:896
    v_mfma_f32_16x16x32_bf16 v[200:203], v[92:95], v[152:155], v[200:203]
    ds_read2_b32 v[68:69], v16 offset0:96 offset1:97
    v_mfma_f32_16x16x32_bf16 v[192:195], v[96:99], v[140:143], v[192:195]
    ds_read2_b32 v[70:71], v16 offset0:98 offset1:99
    v_mfma_f32_16x16x32_bf16 v[196:199], v[96:99], v[144:147], v[196:199]
    ds_read_b128 v[136:139], v7 offset:384
    v_mfma_f32_16x16x32_bf16 v[200:203], v[96:99], v[148:151], v[200:203]
    ds_read2_b32 v[72:73], v16 offset0:224 offset1:225
    v_mfma_f32_16x16x32_bf16 v[196:199], v[100:103], v[140:143], v[196:199]
    ds_read2_b32 v[74:75], v16 offset0:226 offset1:227
    v_mfma_f32_16x16x32_bf16 v[200:203], v[100:103], v[144:147], v[200:203]
    v_mfma_f32_16x16x32_bf16 v[200:203], v[104:107], v[140:143], v[200:203]
    s_waitcnt lgkmcnt(0)
    s_setprio 0
    s_cmp_lg_u32 s56, 0
    s_cbranch_scc1 qs_46
    s_add_u32 s63, s67, 81920
    buffer_load_dwordx4 v[40:43], v9, s[36:39], s63 offen
qs_46:
    v_mfma_f32_16x16x32_bf16 v[188:191], v[44:47], v[124:127], v[188:191]
    ds_read_b128 v[140:143], v7 offset:4032
    v_mfma_f32_16x16x32_bf16 v[192:195], v[44:47], v[128:131], v[192:195]
    ds_read2_b32 v[76:77], v13 offset0:112 offset1:113
    v_mfma_f32_16x16x32_bf16 v[196:199], v[44:47], v[132:135], v[196:199]
    ds_read2_b32 v[78:79], v13 offset0:114 offset1:115
    v_mfma_f32_16x16x32_bf16 v[200:203], v[44:47], v[136:139], v[200:203]
    ds_read_b128 v[144:147], v7 offset:3520
    v_mfma_f32_16x16x32_bf16 v[188:191], v[48:51], v[120:123], v[188:191]
    ds_read2_b32 v[80:81], v13 offset0:240 offset1:241
    v_mfma_f32_16x16x32_bf16 v[192:195], v[48:51], v[124:127], v[192:195]
    ds_read2_b32 v[82:83], v13 offset0:242 offset1:243
    v_mfma_f32_16x16x32_bf16 v[196:199], v[48:51], v[128:131], v[196:199]
    ds_read_b128 v[148:151], v7 offset:3008
    v_mfma_f32_16x16x32_bf16 v[200:203], v[48:51], v[132:135], v[200:203]
    ds_read2_b32 v[84:85], v14 offset0:112 offset1:113
    v_mfma_f32_16x16x32_bf16 v[188:191], v[52:55], v[116:119], v[188:191]
    ds_read2_b32 v[86:87], v14 offset0:114 offset1:115
    v_mfma_f32_16x16x32_bf16 v[192:195], v[52:55], v[120:123], v[192:195]
    ds_read_b128 v[152:155], v7 offset:2496
    v_mfma_f32_16x16x32_bf16 v[196:199], v[52:55], v[124:127], v[196:199]
    ds_read2_b32 v[88:89], v14 offset0:240 offset1:241
    v_mfma_f32_16x16x32_bf16 v[200:203], v[52:55], v[128:131], v[200:203]
    ds_read2_b32 v[90:91], v14 offset0:242 offset1:243
    v_mfma_f32_16x16x32_bf16 v[188:191], v[56:59], v[112:115], v[188:191]
    ds_read_b128 v[156:159], v7 offset:1984
    v_mfma_f32_16x16x32_bf16 v[192:195], v[56:59], v[116:119], v[192:195]
    ds_read2_b32 v[92:93], v15 offset0:112 offset1:113
    v_mfma_f32_16x16x32_bf16 v[196:199], v[56:59], v[120:123], v[196:199]
    ds_read2_b32 v[94:95], v15 offset0:114 offset1:115
    v_mfma_f32_16x16x32_bf16 v[200:203], v[56:59], v[124:127], v[200:203]
    ds_read_b128 v[160:163], v7 offset:1472
    v_mfma_f32_16x16x32_bf16 v[188:191], v[60:63], v[108:111], v[188:191]
    ds_read2_b32 v[96:97], v15 offset0:240 offset1:241
    v_mfma_f32_16x16x32_bf16 v[192:195], v[60:63], v[112:115], v[192:195]
    ds_read2_b32 v[98:99], v15 offset0:242 offset1:243
    v_mfma_f32_16x16x32_bf16 v[196:199], v[60:63], v[116:119], v[196:199]
    ds_read_b128 v[164:167], v7 offset:960
    v_mfma_f32_16x16x32_bf16 v[200:203], v[60:63], v[120:123], v[200:203]
    ds_read2_b32 v[100:101], v16 offset0:112 offset1:113
    v_mfma_f32_16x16x32_bf16 v[192:195], v[64:67], v[108:111], v[192:195]
    ds_read2_b32 v[102:103], v16 offset0:114 offset1:115
    v_mfma_f32_16x16x32_bf16 v[196:199], v[64:67], v[112:115], v[196:199]
    ds_read_b128 v[168:171], v7 offset:448
    v_mfma_f32_16x16x32_bf16 v[200:203], v[64:67], v[116:119], v[200:203]
    ds_read2_b32 v[104:105], v16 offset0:240 offset1:241
    v_mfma_f32_16x16x32_bf16 v[196:199], v[68:71], v[108:111], v[196:199]
    ds_read2_b32 v[106:107], v16 offset0:242 offset1:243
    v_mfma_f32_16x16x32_bf16 v[200:203], v[68:71], v[112:115], v[200:203]
    v_mfma_f32_16x16x32_bf16 v[200:203], v[72:75], v[108:111], v[200:203]
    s_waitcnt lgkmcnt(0)
    s_setprio 0
    v_mfma_f32_16x16x32_bf16 v[188:191], v[76:79], v[156:159], v[188:191]
    ds_read_b128 v[108:111], v7 offset:3584
    v_mfma_f32_16x16x32_bf16 v[192:195], v[76:79], v[160:163], v[192:195]
    ds_read2_b32 v[44:45], v13 offset0:0 offset1:1
    v_mfma_f32_16x16x32_bf16 v[196:199], v[76:79], v[164:167], v[196:199]
    ds_read2_b32 v[46:47], v13 offset0:2 offset1:3
    v_mfma_f32_16x16x32_bf16 v[200:203], v[76:79], v[168:171], v[200:203]
    ds_read_b128 v[112:115], v7 offset:3072
    v_mfma_f32_16x16x32_bf16 v[188:191], v[80:83], v[152:155], v[188:191]
    ds_read2_b32 v[48:49], v13 offset0:128 offset1:129
    v_mfma_f32_16x16x32_bf16 v[192:195], v[80:83], v[156:159], v[192:195]
    ds_read2_b32 v[50:51], v13 offset0:130 offset1:131
    v_mfma_f32_16x16x32_bf16 v[196:199], v[80:83], v[160:163], v[196:199]
    ds_read_b128 v[116:119], v7 offset:2560
    v_mfma_f32_16x16x32_bf16 v[200:203], v[80:83], v[164:167], v[200:203]
    ds_read2_b32 v[52:53], v14 offset0:0 offset1:1
    v_mfma_f32_16x16x32_bf16 v[188:191], v[84:87], v[148:151], v[188:191]
    ds_read2_b32 v[54:55], v14 offset0:2 offset1:3
    v_mfma_f32_16x16x32_bf16 v[192:195], v[84:87], v[152:155], v[192:195]
    ds_read_b128 v[120:123], v7 offset:2048
    v_mfma_f32_16x16x32_bf16 v[196:199], v[84:87], v[156:159], v[196:199]
    ds_read2_b32 v[56:57], v14 offset0:128 offset1:129
    v_mfma_f32_16x16x32_bf16 v[200:203], v[84:87], v[160:163], v[200:203]
    ds_read2_b32 v[58:59], v14 offset0:130 offset1:131
    v_mfma_f32_16x16x32_bf16 v[188:191], v[88:91], v[144:147], v[188:191]
    ds_read_b128 v[124:127], v7 offset:3648
    v_mfma_f32_16x16x32_bf16 v[192:195], v[88:91], v[148:151], v[192:195]
    ds_read2_b32 v[60:61], v13 offset0:16 offset1:17
    v_mfma_f32_16x16x32_bf16 v[196:199], v[88:91], v[152:155], v[196:199]
    ds_read2_b32 v[62:63], v13 offset0:18 offset1:19
    v_mfma_f32_16x16x32_bf16 v[200:203], v[88:91], v[156:159], v[200:203]
    ds_read_b128 v[128:131], v7 offset:3136
    v_mfma_f32_16x16x32_bf16 v[188:191], v[92:95], v[140:143], v[188:191]
    ds_read2_b32 v[64:65], v13 offset0:144 offset1:145
    v_mfma_f32_16x16x32_bf16 v[192:195], v[92:95], v[144:147], v[192:195]
    ds_read2_b32 v[66:67], v13 offset0:146 offset1:147
    v_mfma_f32_16x16x32_bf16 v[196:199], v[92:95], v[148:151], v[196:199]
    ds_read_b128 v[132:135], v7 offset:2624
    v_mfma_f32_16x16x32_bf16 v[200:203], v[92:95], v[152:155], v[200:203]
    ds_read2_b32 v[68:69], v14 offset0:16 offset1:17
    v_mfma_f32_16x16x32_bf16 v[192:195], v[96:99], v[140:143], v[192:195]
    ds_read2_b32 v[70:71], v14 offset0:18 offset1:19
    v_mfma_f32_16x16x32_bf16 v[196:199], v[96:99], v[144:147], v[196:199]
    ds_read_b128 v[136:139], v7 offset:2112
    v_mfma_f32_16x16x32_bf16 v[200:203], v[96:99], v[148:151], v[200:203]
    ds_read2_b32 v[72:73], v14 offset0:144 offset1:145
    v_mfma_f32_16x16x32_bf16 v[196:199], v[100:103], v[140:143], v[196:199]
    ds_read2_b32 v[74:75], v14 offset0:146 offset1:147
    v_mfma_f32_16x16x32_bf16 v[200:203], v[100:103], v[144:147], v[200:203]
    v_mfma_f32_16x16x32_bf16 v[200:203], v[104:107], v[140:143], v[200:203]
    s_nop 3
    v_cvt_pk_bf16_f32 v188, v188, v189
    v_cvt_pk_bf16_f32 v189, v190, v191
    ds_write_b64 v8, v[188:189] offset:0
    v_cvt_pk_bf16_f32 v192, v192, v193
    v_cvt_pk_bf16_f32 v193, v194, v195
    ds_write_b64 v8, v[192:193] offset:512
    v_cvt_pk_bf16_f32 v196, v196, v197
    v_cvt_pk_bf16_f32 v197, v198, v199
    ds_write_b64 v8, v[196:197] offset:1024
    v_cvt_pk_bf16_f32 v200, v200, v201
    v_cvt_pk_bf16_f32 v201, v202, v203
    ds_write_b64 v8, v[200:201] offset:1536
    s_waitcnt lgkmcnt(0)
    s_barrier
    s_cmp_eq_u32 s56, 0
    s_cbranch_scc1 full_47
    ds_read_b64_tr_b16 v[188:189], v12 offset:0
    ds_read_b64_tr_b16 v[190:191], v12 offset:8448
    ds_read_b64_tr_b16 v[192:193], v12 offset:128
    ds_read_b64_tr_b16 v[194:195], v12 offset:8576
    s_waitcnt vmcnt(0) lgkmcnt(0)
    v_lshlrev_b32 v196, 16, v188
    v_and_b32 v197, 0xffff0000, v188
    v_lshlrev_b32 v198, 16, v28
    v_and_b32 v199, 0xffff0000, v28
    v_mul_f32 v196, v196, v198
    v_mul_f32 v197, v197, v199
    v_cvt_pk_bf16_f32 v188, v196, v197
    v_lshlrev_b32 v200, 16, v189
    v_and_b32 v201, 0xffff0000, v189
    v_lshlrev_b32 v202, 16, v29
    v_and_b32 v203, 0xffff0000, v29
    v_mul_f32 v200, v200, v202
    v_mul_f32 v201, v201, v203
    v_cvt_pk_bf16_f32 v189, v200, v201
    v_lshlrev_b32 v196, 16, v190
    v_and_b32 v197, 0xffff0000, v190
    v_lshlrev_b32 v198, 16, v30
    v_and_b32 v199, 0xffff0000, v30
    v_mul_f32 v196, v196, v198
    v_mul_f32 v197, v197, v199
    v_cvt_pk_bf16_f32 v190, v196, v197
    v_lshlrev_b32 v200, 16, v191
    v_and_b32 v201, 0xffff0000, v191
    v_lshlrev_b32 v202, 16, v31
    v_and_b32 v203, 0xffff0000, v31
    v_mul_f32 v200, v200, v202
    v_mul_f32 v201, v201, v203
    v_cvt_pk_bf16_f32 v191, v200, v201
    s_add_u32 s63, s64, 2621440
    buffer_store_dwordx4 v[188:191], v11, s[40:43], s63 offen
    v_lshlrev_b32 v196, 16, v192
    v_and_b32 v197, 0xffff0000, v192
    v_lshlrev_b32 v198, 16, v32
    v_and_b32 v199, 0xffff0000, v32
    v_mul_f32 v196, v196, v198
    v_mul_f32 v197, v197, v199
    v_cvt_pk_bf16_f32 v192, v196, v197
    v_lshlrev_b32 v200, 16, v193
    v_and_b32 v201, 0xffff0000, v193
    v_lshlrev_b32 v202, 16, v33
    v_and_b32 v203, 0xffff0000, v33
    v_mul_f32 v200, v200, v202
    v_mul_f32 v201, v201, v203
    v_cvt_pk_bf16_f32 v193, v200, v201
    v_lshlrev_b32 v196, 16, v194
    v_and_b32 v197, 0xffff0000, v194
    v_lshlrev_b32 v198, 16, v34
    v_and_b32 v199, 0xffff0000, v34
    v_mul_f32 v196, v196, v198
    v_mul_f32 v197, v197, v199
    v_cvt_pk_bf16_f32 v194, v196, v197
    v_lshlrev_b32 v200, 16, v195
    v_and_b32 v201, 0xffff0000, v195
    v_lshlrev_b32 v202, 16, v35
    v_and_b32 v203, 0xffff0000, v35
    v_mul_f32 v200, v200, v202
    v_mul_f32 v201, v201, v203
    v_cvt_pk_bf16_f32 v195, v200, v201
    s_add_u32 s63, s64, 2785280
    buffer_store_dwordx4 v[192:195], v11, s[40:43], s63 offen
    s_branch L_FIN
full_47:
    s_setprio 3
    v_mfma_f32_16x16x32_bf16 v[172:175], v[44:47], v[108:111], v[172:175]
    ds_read_b64_tr_b16 v[188:189], v12 offset:0
    ds_read_b64_tr_b16 v[190:191], v12 offset:8448
    v_mfma_f32_16x16x32_bf16 v[176:179], v[44:47], v[112:115], v[176:179]
    ds_read_b64_tr_b16 v[192:193], v12 offset:128
    v_mfma_f32_16x16x32_bf16 v[180:183], v[44:47], v[116:119], v[180:183]
    ds_read_b64_tr_b16 v[194:195], v12 offset:8576
    ds_read_b128 v[140:143], v7 offset:3712
    v_mfma_f32_16x16x32_bf16 v[184:187], v[44:47], v[120:123], v[184:187]
    ds_read2_b32 v[76:77], v13 offset0:32 offset1:33
    v_mfma_f32_16x16x32_bf16 v[176:179], v[48:51], v[108:111], v[176:179]
    ds_read2_b32 v[78:79], v13 offset0:34 offset1:35
    v_mfma_f32_16x16x32_bf16 v[180:183], v[48:51], v[112:115], v[180:183]
    ds_read_b128 v[144:147], v7 offset:3200
    ds_read2_b32 v[80:81], v13 offset0:160 offset1:161
    v_mfma_f32_16x16x32_bf16 v[184:187], v[48:51], v[116:119], v[184:187]
    ds_read2_b32 v[82:83], v13 offset0:162 offset1:163
    v_mfma_f32_16x16x32_bf16 v[180:183], v[52:55], v[108:111], v[180:183]
    ds_read_b128 v[148:151], v7 offset:2688
    ds_read2_b32 v[84:85], v14 offset0:32 offset1:33
    v_mfma_f32_16x16x32_bf16 v[184:187], v[52:55], v[112:115], v[184:187]
    ds_read2_b32 v[86:87], v14 offset0:34 offset1:35
    v_mfma_f32_16x16x32_bf16 v[184:187], v[56:59], v[108:111], v[184:187]
    ds_read_b128 v[152:155], v7 offset:2176
    v_mfma_f32_16x16x32_bf16 v[172:175], v[60:63], v[124:127], v[172:175]
    ds_read2_b32 v[88:89], v14 offset0:160 offset1:161
    ds_read2_b32 v[90:91], v14 offset0:162 offset1:163
    v_mfma_f32_16x16x32_bf16 v[176:179], v[60:63], v[128:131], v[176:179]
    ds_read_b128 v[156:159], v7 offset:3776
    v_mfma_f32_16x16x32_bf16 v[180:183], v[60:63], v[132:135], v[180:183]
    ds_read2_b32 v[92:93], v13 offset0:48 offset1:49
    ds_read2_b32 v[94:95], v13 offset0:50 offset1:51
    v_mfma_f32_16x16x32_bf16 v[184:187], v[60:63], v[136:139], v[184:187]
    ds_read_b128 v[160:163], v7 offset:3264
    v_mfma_f32_16x16x32_bf16 v[176:179], v[64:67], v[124:127], v[176:179]
    ds_read2_b32 v[96:97], v13 offset0:176 offset1:177
    v_mfma_f32_16x16x32_bf16 v[180:183], v[64:67], v[128:131], v[180:183]
    ds_read2_b32 v[98:99], v13 offset0:178 offset1:179
    ds_read_b128 v[164:167], v7 offset:2752
    v_mfma_f32_16x16x32_bf16 v[184:187], v[64:67], v[132:135], v[184:187]
    ds_read2_b32 v[100:101], v14 offset0:48 offset1:49
    v_mfma_f32_16x16x32_bf16 v[180:183], v[68:71], v[124:127], v[180:183]
    ds_read2_b32 v[102:103], v14 offset0:50 offset1:51
    ds_read_b128 v[168:171], v7 offset:2240
    v_mfma_f32_16x16x32_bf16 v[184:187], v[68:71], v[128:131], v[184:187]
    ds_read2_b32 v[104:105], v14 offset0:176 offset1:177
    v_mfma_f32_16x16x32_bf16 v[184:187], v[72:75], v[124:127], v[184:187]
    ds_read2_b32 v[106:107], v14 offset0:178 offset1:179
    s_waitcnt lgkmcnt(0)
    s_setprio 2
    s_waitcnt vmcnt(2)
    v_mfma_f32_16x16x32_bf16 v[172:175], v[76:79], v[140:143], v[172:175]
    ds_read_b128 v[108:111], v7 offset:3840
    v_lshlrev_b32 v196, 16, v188
    ds_read2_b32 v[44:45], v13 offset0:64 offset1:65
    v_mfma_f32_16x16x32_bf16 v[176:179], v[76:79], v[144:147], v[176:179]
    v_and_b32 v197, 0xffff0000, v188
    ds_read2_b32 v[46:47], v13 offset0:66 offset1:67
    v_lshlrev_b32 v198, 16, v28
    v_mfma_f32_16x16x32_bf16 v[180:183], v[76:79], v[148:151], v[180:183]
    ds_read_b128 v[112:115], v7 offset:3328
    v_and_b32 v199, 0xffff0000, v28
    ds_read2_b32 v[48:49], v13 offset0:192 offset1:193
    v_mfma_f32_16x16x32_bf16 v[184:187], v[76:79], v[152:155], v[184:187]
    v_mul_f32 v196, v196, v198
    ds_read2_b32 v[50:51], v13 offset0:194 offset1:195
    v_mfma_f32_16x16x32_bf16 v[176:179], v[80:83], v[140:143], v[176:179]
    v_mul_f32 v197, v197, v199
    ds_read_b128 v[116:119], v7 offset:2816
    v_cvt_pk_bf16_f32 v188, v196, v197
    v_mfma_f32_16x16x32_bf16 v[180:183], v[80:83], v[144:147], v[180:183]
    ds_read2_b32 v[52:53], v14 offset0:64 offset1:65
    v_lshlrev_b32 v200, 16, v189
    ds_read2_b32 v[54:55], v14 offset0:66 offset1:67
    v_mfma_f32_16x16x32_bf16 v[184:187], v[80:83], v[148:151], v[184:187]
    v_and_b32 v201, 0xffff0000, v189
    ds_read_b128 v[120:123], v7 offset:2304
    v_mfma_f32_16x16x32_bf16 v[180:183], v[84:87], v[140:143], v[180:183]
    v_lshlrev_b32 v202, 16, v29
    ds_read2_b32 v[56:57], v14 offset0:192 offset1:193
    v_and_b32 v203, 0xffff0000, v29
    v_mfma_f32_16x16x32_bf16 v[184:187], v[84:87], v[144:147], v[184:187]
    ds_read2_b32 v[58:59], v14 offset0:194 offset1:195
    v_mul_f32 v200, v200, v202
    ds_read_b128 v[124:127], v7 offset:3904
    v_mfma_f32_16x16x32_bf16 v[184:187], v[88:91], v[140:143], v[184:187]
    v_mul_f32 v201, v201, v203
    ds_read2_b32 v[60:61], v13 offset0:80 offset1:81
    v_mfma_f32_16x16x32_bf16 v[172:175], v[92:95], v[156:159], v[172:175]
    v_cvt_pk_bf16_f32 v189, v200, v201
    ds_read2_b32 v[62:63], v13 offset0:82 offset1:83
    v_lshlrev_b32 v196, 16, v190
    v_mfma_f32_16x16x32_bf16 v[176:179], v[92:95], v[160:163], v[176:179]
    ds_read_b128 v[128:131], v7 offset:3392
    v_and_b32 v197, 0xffff0000, v190
    ds_read2_b32 v[64:65], v13 offset0:208 offset1:209
    v_mfma_f32_16x16x32_bf16 v[180:183], v[92:95], v[164:167], v[180:183]
    v_lshlrev_b32 v198, 16, v30
    ds_read2_b32 v[66:67], v13 offset0:210 offset1:211
    v_and_b32 v199, 0xffff0000, v30
    v_mfma_f32_16x16x32_bf16 v[184:187], v[92:95], v[168:171], v[184:187]
    ds_read_b128 v[132:135], v7 offset:2880
    v_mul_f32 v196, v196, v198
    v_mfma_f32_16x16x32_bf16 v[176:179], v[96:99], v[156:159], v[176:179]
    ds_read2_b32 v[68:69], v14 offset0:80 offset1:81
    v_mul_f32 v197, v197, v199
    ds_read2_b32 v[70:71], v14 offset0:82 offset1:83
    v_mfma_f32_16x16x32_bf16 v[180:183], v[96:99], v[160:163], v[180:183]
    v_cvt_pk_bf16_f32 v190, v196, v197
    ds_read_b128 v[136:139], v7 offset:2368
    v_lshlrev_b32 v200, 16, v191
    v_mfma_f32_16x16x32_bf16 v[184:187], v[96:99], v[164:167], v[184:187]
    ds_read2_b32 v[72:73], v14 offset0:208 offset1:209
    v_and_b32 v201, 0xffff0000, v191
    v_mfma_f32_16x16x32_bf16 v[180:183], v[100:103], v[156:159], v[180:183]
    ds_read2_b32 v[74:75], v14 offset0:210 offset1:211
    v_lshlrev_b32 v202, 16, v31
    v_and_b32 v203, 0xffff0000, v31
    v_mfma_f32_16x16x32_bf16 v[184:187], v[100:103], v[160:163], v[184:187]
    v_mul_f32 v200, v200, v202
    v_mul_f32 v201, v201, v203
    v_cvt_pk_bf16_f32 v191, v200, v201
    v_mfma_f32_16x16x32_bf16 v[184:187], v[104:107], v[156:159], v[184:187]
    s_add_u32 s63, s64, 2621440
    buffer_store_dwordx4 v[188:191], v11, s[40:43], s63 offen
    s_waitcnt lgkmcnt(0)
    s_setprio 1
    v_mfma_f32_16x16x32_bf16 v[172:175], v[44:47], v[108:111], v[172:175]
    ds_read_b128 v[140:143], v7 offset:3968
    v_lshlrev_b32 v196, 16, v192
    ds_read2_b32 v[76:77], v13 offset0:96 offset1:97
    v_mfma_f32_16x16x32_bf16 v[176:179], v[44:47], v[112:115], v[176:179]
    v_and_b32 v197, 0xffff0000, v192
    ds_read2_b32 v[78:79], v13 offset0:98 offset1:99
    v_lshlrev_b32 v198, 16, v32
    v_mfma_f32_16x16x32_bf16 v[180:183], v[44:47], v[116:119], v[180:183]
    ds_read_b128 v[144:147], v7 offset:3456
    v_and_b32 v199, 0xffff0000, v32
    ds_read2_b32 v[80:81], v13 offset0:224 offset1:225
    v_mfma_f32_16x16x32_bf16 v[184:187], v[44:47], v[120:123], v[184:187]
    v_mul_f32 v196, v196, v198
    ds_read2_b32 v[82:83], v13 offset0:226 offset1:227
    v_mfma_f32_16x16x32_bf16 v[176:179], v[48:51], v[108:111], v[176:179]
    v_mul_f32 v197, v197, v199
    ds_read_b128 v[148:151], v7 offset:2944
    v_cvt_pk_bf16_f32 v192, v196, v197
    v_mfma_f32_16x16x32_bf16 v[180:183], v[48:51], v[112:115], v[180:183]
    ds_read2_b32 v[84:85], v14 offset0:96 offset1:97
    v_lshlrev_b32 v200, 16, v193
    ds_read2_b32 v[86:87], v14 offset0:98 offset1:99
    v_mfma_f32_16x16x32_bf16 v[184:187], v[48:51], v[116:119], v[184:187]
    v_and_b32 v201, 0xffff0000, v193
    ds_read_b128 v[152:155], v7 offset:2432
    v_mfma_f32_16x16x32_bf16 v[180:183], v[52:55], v[108:111], v[180:183]
    v_lshlrev_b32 v202, 16, v33
    ds_read2_b32 v[88:89], v14 offset0:224 offset1:225
    v_and_b32 v203, 0xffff0000, v33
    v_mfma_f32_16x16x32_bf16 v[184:187], v[52:55], v[112:115], v[184:187]
    ds_read2_b32 v[90:91], v14 offset0:226 offset1:227
    v_mul_f32 v200, v200, v202
    ds_read_b128 v[156:159], v7 offset:4032
    v_mfma_f32_16x16x32_bf16 v[184:187], v[56:59], v[108:111], v[184:187]
    v_mul_f32 v201, v201, v203
    ds_read2_b32 v[92:93], v13 offset0:112 offset1:113
    v_mfma_f32_16x16x32_bf16 v[172:175], v[60:63], v[124:127], v[172:175]
    v_cvt_pk_bf16_f32 v193, v200, v201
    ds_read2_b32 v[94:95], v13 offset0:114 offset1:115
    v_lshlrev_b32 v196, 16, v194
    v_mfma_f32_16x16x32_bf16 v[176:179], v[60:63], v[128:131], v[176:179]
    ds_read_b128 v[160:163], v7 offset:3520
    v_and_b32 v197, 0xffff0000, v194
    ds_read2_b32 v[96:97], v13 offset0:240 offset1:241
    v_mfma_f32_16x16x32_bf16 v[180:183], v[60:63], v[132:135], v[180:183]
    v_lshlrev_b32 v198, 16, v34
    ds_read2_b32 v[98:99], v13 offset0:242 offset1:243
    v_and_b32 v199, 0xffff0000, v34
    v_mfma_f32_16x16x32_bf16 v[184:187], v[60:63], v[136:139], v[184:187]
    ds_read_b128 v[164:167], v7 offset:3008
    v_mul_f32 v196, v196, v198
    v_mfma_f32_16x16x32_bf16 v[176:179], v[64:67], v[124:127], v[176:179]
    ds_read2_b32 v[100:101], v14 offset0:112 offset1:113
    v_mul_f32 v197, v197, v199
    ds_read2_b32 v[102:103], v14 offset0:114 offset1:115
    v_mfma_f32_16x16x32_bf16 v[180:183], v[64:67], v[128:131], v[180:183]
    v_cvt_pk_bf16_f32 v194, v196, v197
    ds_read_b128 v[168:171], v7 offset:2496
    v_lshlrev_b32 v200, 16, v195
    v_mfma_f32_16x16x32_bf16 v[184:187], v[64:67], v[132:135], v[184:187]
    ds_read2_b32 v[104:105], v14 offset0:240 offset1:241
    v_and_b32 v201, 0xffff0000, v195
    v_mfma_f32_16x16x32_bf16 v[180:183], v[68:71], v[124:127], v[180:183]
    ds_read2_b32 v[106:107], v14 offset0:242 offset1:243
    v_lshlrev_b32 v202, 16, v35
    v_and_b32 v203, 0xffff0000, v35
    v_mfma_f32_16x16x32_bf16 v[184:187], v[68:71], v[128:131], v[184:187]
    v_mul_f32 v200, v200, v202
    v_mul_f32 v201, v201, v203
    v_cvt_pk_bf16_f32 v195, v200, v201
    v_mfma_f32_16x16x32_bf16 v[184:187], v[72:75], v[124:127], v[184:187]
    s_add_u32 s63, s64, 2785280
    buffer_store_dwordx4 v[192:195], v11, s[40:43], s63 offen
    s_waitcnt lgkmcnt(0)
    s_setprio 0
    v_mfma_f32_16x16x32_bf16 v[172:175], v[76:79], v[140:143], v[172:175]
    v_mfma_f32_16x16x32_bf16 v[176:179], v[76:79], v[144:147], v[176:179]
    v_mfma_f32_16x16x32_bf16 v[180:183], v[76:79], v[148:151], v[180:183]
    v_mfma_f32_16x16x32_bf16 v[184:187], v[76:79], v[152:155], v[184:187]
    v_mfma_f32_16x16x32_bf16 v[176:179], v[80:83], v[140:143], v[176:179]
    v_mfma_f32_16x16x32_bf16 v[180:183], v[80:83], v[144:147], v[180:183]
    v_mfma_f32_16x16x32_bf16 v[184:187], v[80:83], v[148:151], v[184:187]
    v_mfma_f32_16x16x32_bf16 v[180:183], v[84:87], v[140:143], v[180:183]
    v_mfma_f32_16x16x32_bf16 v[184:187], v[84:87], v[144:147], v[184:187]
    v_mfma_f32_16x16x32_bf16 v[184:187], v[88:91], v[140:143], v[184:187]
    v_mfma_f32_16x16x32_bf16 v[172:175], v[92:95], v[156:159], v[172:175]
    v_mfma_f32_16x16x32_bf16 v[176:179], v[92:95], v[160:163], v[176:179]
    v_mfma_f32_16x16x32_bf16 v[180:183], v[92:95], v[164:167], v[180:183]
    v_mfma_f32_16x16x32_bf16 v[184:187], v[92:95], v[168:171], v[184:187]
    v_mfma_f32_16x16x32_bf16 v[176:179], v[96:99], v[156:159], v[176:179]
    v_mfma_f32_16x16x32_bf16 v[180:183], v[96:99], v[160:163], v[180:183]
    v_mfma_f32_16x16x32_bf16 v[184:187], v[96:99], v[164:167], v[184:187]
    v_mfma_f32_16x16x32_bf16 v[180:183], v[100:103], v[156:159], v[180:183]
    v_mfma_f32_16x16x32_bf16 v[184:187], v[100:103], v[160:163], v[184:187]
    v_mfma_f32_16x16x32_bf16 v[184:187], v[104:107], v[156:159], v[184:187]
    s_branch loj_42
lo4_41:
    ds_read_b128 v[108:111], v7 offset:3584
    ds_read2_b32 v[44:45], v13 offset0:0 offset1:1
    ds_read2_b32 v[46:47], v13 offset0:2 offset1:3
    ds_read_b128 v[112:115], v7 offset:3072
    ds_read2_b32 v[48:49], v13 offset0:128 offset1:129
    ds_read2_b32 v[50:51], v13 offset0:130 offset1:131
    ds_read_b128 v[116:119], v7 offset:2560
    ds_read2_b32 v[52:53], v14 offset0:0 offset1:1
    ds_read2_b32 v[54:55], v14 offset0:2 offset1:3
    ds_read_b128 v[120:123], v7 offset:2048
    ds_read2_b32 v[56:57], v14 offset0:128 offset1:129
    ds_read2_b32 v[58:59], v14 offset0:130 offset1:131
    ds_read_b128 v[124:127], v7 offset:3648
    ds_read2_b32 v[60:61], v13 offset0:16 offset1:17
    ds_read2_b32 v[62:63], v13 offset0:18 offset1:19
    ds_read_b128 v[128:131], v7 offset:3136
    ds_read2_b32 v[64:65], v13 offset0:144 offset1:145
    ds_read2_b32 v[66:67], v13 offset0:146 offset1:147
    ds_read_b128 v[132:135], v7 offset:2624
    ds_read2_b32 v[68:69], v14 offset0:16 offset1:17
    ds_read2_b32 v[70:71], v14 offset0:18 offset1:19
    ds_read_b128 v[136:139], v7 offset:2112
    ds_read2_b32 v[72:73], v14 offset0:144 offset1:145
    ds_read2_b32 v[74:75], v14 offset0:146 offset1:147
    s_waitcnt lgkmcnt(0)
    v_mfma_f32_16x16x32_bf16 v[172:175], v[24:27], v[108:111], 0
    ds_read_b128 v[140:143], v7 offset:3712
    v_mfma_f32_16x16x32_bf16 v[176:179], v[24:27], v[112:115], 0
    ds_read2_b32 v[76:77], v13 offset0:32 offset1:33
    v_mfma_f32_16x16x32_bf16 v[180:183], v[24:27], v[116:119], 0
    ds_read2_b32 v[78:79], v13 offset0:34 offset1:35
    v_mfma_f32_16x16x32_bf16 v[184:187], v[24:27], v[120:123], 0
    ds_read_b128 v[144:147], v7 offset:3200
    v_mfma_f32_16x16x32_bf16 v[172:175], v[44:47], v[108:111], v[172:175]
    ds_read2_b32 v[80:81], v13 offset0:160 offset1:161
    v_mfma_f32_16x16x32_bf16 v[176:179], v[44:47], v[112:115], v[176:179]
    ds_read2_b32 v[82:83], v13 offset0:162 offset1:163
    v_mfma_f32_16x16x32_bf16 v[180:183], v[44:47], v[116:119], v[180:183]
    ds_read_b128 v[148:151], v7 offset:2688
    v_mfma_f32_16x16x32_bf16 v[184:187], v[44:47], v[120:123], v[184:187]
    ds_read2_b32 v[84:85], v14 offset0:32 offset1:33
    v_mfma_f32_16x16x32_bf16 v[176:179], v[48:51], v[108:111], v[176:179]
    ds_read2_b32 v[86:87], v14 offset0:34 offset1:35
    v_mfma_f32_16x16x32_bf16 v[180:183], v[48:51], v[112:115], v[180:183]
    ds_read_b128 v[152:155], v7 offset:2176
    v_mfma_f32_16x16x32_bf16 v[184:187], v[48:51], v[116:119], v[184:187]
    ds_read2_b32 v[88:89], v14 offset0:160 offset1:161
    v_mfma_f32_16x16x32_bf16 v[180:183], v[52:55], v[108:111], v[180:183]
    ds_read2_b32 v[90:91], v14 offset0:162 offset1:163
    v_mfma_f32_16x16x32_bf16 v[184:187], v[52:55], v[112:115], v[184:187]
    ds_read_b128 v[156:159], v7 offset:3776
    v_mfma_f32_16x16x32_bf16 v[184:187], v[56:59], v[108:111], v[184:187]
    ds_read2_b32 v[92:93], v13 offset0:48 offset1:49
    v_mfma_f32_16x16x32_bf16 v[172:175], v[60:63], v[124:127], v[172:175]
    ds_read2_b32 v[94:95], v13 offset0:50 offset1:51
    v_mfma_f32_16x16x32_bf16 v[176:179], v[60:63], v[128:131], v[176:179]
    ds_read_b128 v[160:163], v7 offset:3264
    v_mfma_f32_16x16x32_bf16 v[180:183], v[60:63], v[132:135], v[180:183]
    ds_read2_b32 v[96:97], v13 offset0:176 offset1:177
    v_mfma_f32_16x16x32_bf16 v[184:187], v[60:63], v[136:139], v[184:187]
    ds_read2_b32 v[98:99], v13 offset0:178 offset1:179
    v_mfma_f32_16x16x32_bf16 v[176:179], v[64:67], v[124:127], v[176:179]
    ds_read_b128 v[164:167], v7 offset:2752
    v_mfma_f32_16x16x32_bf16 v[180:183], v[64:67], v[128:131], v[180:183]
    ds_read2_b32 v[100:101], v14 offset0:48 offset1:49
    v_mfma_f32_16x16x32_bf16 v[184:187], v[64:67], v[132:135], v[184:187]
    ds_read2_b32 v[102:103], v14 offset0:50 offset1:51
    v_mfma_f32_16x16x32_bf16 v[180:183], v[68:71], v[124:127], v[180:183]
    ds_read_b128 v[168:171], v7 offset:2240
    v_mfma_f32_16x16x32_bf16 v[184:187], v[68:71], v[128:131], v[184:187]
    ds_read2_b32 v[104:105], v14 offset0:176 offset1:177
    v_mfma_f32_16x16x32_bf16 v[184:187], v[72:75], v[124:127], v[184:187]
    ds_read2_b32 v[106:107], v14 offset0:178 offset1:179
    s_waitcnt lgkmcnt(0)
    v_mfma_f32_16x16x32_bf16 v[172:175], v[76:79], v[140:143], v[172:175]
    ds_read_b128 v[108:111], v7 offset:3840
    ds_read2_b32 v[44:45], v13 offset0:64 offset1:65
    v_mfma_f32_16x16x32_bf16 v[176:179], v[76:79], v[144:147], v[176:179]
    ds_read2_b32 v[46:47], v13 offset0:66 offset1:67
    v_mfma_f32_16x16x32_bf16 v[180:183], v[76:79], v[148:151], v[180:183]
    ds_read_b128 v[112:115], v7 offset:3328
    v_mfma_f32_16x16x32_bf16 v[184:187], v[76:79], v[152:155], v[184:187]
    ds_read2_b32 v[48:49], v13 offset0:192 offset1:193
    v_mfma_f32_16x16x32_bf16 v[176:179], v[80:83], v[140:143], v[176:179]
    ds_read2_b32 v[50:51], v13 offset0:194 offset1:195
    v_mfma_f32_16x16x32_bf16 v[180:183], v[80:83], v[144:147], v[180:183]
    ds_read_b128 v[116:119], v7 offset:2816
    ds_read2_b32 v[52:53], v14 offset0:64 offset1:65
    v_mfma_f32_16x16x32_bf16 v[184:187], v[80:83], v[148:151], v[184:187]
    ds_read2_b32 v[54:55], v14 offset0:66 offset1:67
    v_mfma_f32_16x16x32_bf16 v[180:183], v[84:87], v[140:143], v[180:183]
    ds_read_b128 v[120:123], v7 offset:2304
    v_mfma_f32_16x16x32_bf16 v[184:187], v[84:87], v[144:147], v[184:187]
    ds_read2_b32 v[56:57], v14 offset0:192 offset1:193
    v_mfma_f32_16x16x32_bf16 v[184:187], v[88:91], v[140:143], v[184:187]
    ds_read2_b32 v[58:59], v14 offset0:194 offset1:195
    v_mfma_f32_16x16x32_bf16 v[172:175], v[92:95], v[156:159], v[172:175]
    ds_read_b128 v[124:127], v7 offset:3904
    ds_read2_b32 v[60:61], v13 offset0:80 offset1:81
    v_mfma_f32_16x16x32_bf16 v[176:179], v[92:95], v[160:163], v[176:179]
    ds_read2_b32 v[62:63], v13 offset0:82 offset1:83
    v_mfma_f32_16x16x32_bf16 v[180:183], v[92:95], v[164:167], v[180:183]
    ds_read_b128 v[128:131], v7 offset:3392
    v_mfma_f32_16x16x32_bf16 v[184:187], v[92:95], v[168:171], v[184:187]
    ds_read2_b32 v[64:65], v13 offset0:208 offset1:209
    v_mfma_f32_16x16x32_bf16 v[176:179], v[96:99], v[156:159], v[176:179]
    ds_read2_b32 v[66:67], v13 offset0:210 offset1:211
    v_mfma_f32_16x16x32_bf16 v[180:183], v[96:99], v[160:163], v[180:183]
    ds_read_b128 v[132:135], v7 offset:2880
    ds_read2_b32 v[68:69], v14 offset0:80 offset1:81
    v_mfma_f32_16x16x32_bf16 v[184:187], v[96:99], v[164:167], v[184:187]
    ds_read2_b32 v[70:71], v14 offset0:82 offset1:83
    v_mfma_f32_16x16x32_bf16 v[180:183], v[100:103], v[156:159], v[180:183]
    ds_read_b128 v[136:139], v7 offset:2368
    v_mfma_f32_16x16x32_bf16 v[184:187], v[100:103], v[160:163], v[184:187]
    ds_read2_b32 v[72:73], v14 offset0:208 offset1:209
    v_mfma_f32_16x16x32_bf16 v[184:187], v[104:107], v[156:159], v[184:187]
    ds_read2_b32 v[74:75], v14 offset0:210 offset1:211
    s_waitcnt lgkmcnt(0)
    s_add_u32 s63, s67, 0
    buffer_load_dwordx4 v[36:39], v9, s[36:39], s63 offen
    v_mfma_f32_16x16x32_bf16 v[172:175], v[44:47], v[108:111], v[172:175]
    ds_read_b128 v[140:143], v7 offset:3968
    ds_read2_b32 v[76:77], v13 offset0:96 offset1:97
    v_mfma_f32_16x16x32_bf16 v[176:179], v[44:47], v[112:115], v[176:179]
    ds_read2_b32 v[78:79], v13 offset0:98 offset1:99
    v_mfma_f32_16x16x32_bf16 v[180:183], v[44:47], v[116:119], v[180:183]
    ds_read_b128 v[144:147], v7 offset:3456
    v_mfma_f32_16x16x32_bf16 v[184:187], v[44:47], v[120:123], v[184:187]
    ds_read2_b32 v[80:81], v13 offset0:224 offset1:225
    v_mfma_f32_16x16x32_bf16 v[176:179], v[48:51], v[108:111], v[176:179]
    ds_read2_b32 v[82:83], v13 offset0:226 offset1:227
    v_mfma_f32_16x16x32_bf16 v[180:183], v[48:51], v[112:115], v[180:183]
    ds_read_b128 v[148:151], v7 offset:2944
    ds_read2_b32 v[84:85], v14 offset0:96 offset1:97
    v_mfma_f32_16x16x32_bf16 v[184:187], v[48:51], v[116:119], v[184:187]
    ds_read2_b32 v[86:87], v14 offset0:98 offset1:99
    v_mfma_f32_16x16x32_bf16 v[180:183], v[52:55], v[108:111], v[180:183]
    ds_read_b128 v[152:155], v7 offset:2432
    v_mfma_f32_16x16x32_bf16 v[184:187], v[52:55], v[112:115], v[184:187]
    ds_read2_b32 v[88:89], v14 offset0:224 offset1:225
    v_mfma_f32_16x16x32_bf16 v[184:187], v[56:59], v[108:111], v[184:187]
    ds_read2_b32 v[90:91], v14 offset0:226 offset1:227
    v_mfma_f32_16x16x32_bf16 v[172:175], v[60:63], v[124:127], v[172:175]
    ds_read_b128 v[156:159], v7 offset:4032
    ds_read2_b32 v[92:93], v13 offset0:112 offset1:113
    v_mfma_f32_16x16x32_bf16 v[176:179], v[60:63], v[128:131], v[176:179]
    ds_read2_b32 v[94:95], v13 offset0:114 offset1:115
    v_mfma_f32_16x16x32_bf16 v[180:183], v[60:63], v[132:135], v[180:183]
    ds_read_b128 v[160:163], v7 offset:3520
    v_mfma_f32_16x16x32_bf16 v[184:187], v[60:63], v[136:139], v[184:187]
    ds_read2_b32 v[96:97], v13 offset0:240 offset1:241
    v_mfma_f32_16x16x32_bf16 v[176:179], v[64:67], v[124:127], v[176:179]
    ds_read2_b32 v[98:99], v13 offset0:242 offset1:243
    v_mfma_f32_16x16x32_bf16 v[180:183], v[64:67], v[128:131], v[180:183]
    ds_read_b128 v[164:167], v7 offset:3008
    ds_read2_b32 v[100:101], v14 offset0:112 offset1:113
    v_mfma_f32_16x16x32_bf16 v[184:187], v[64:67], v[132:135], v[184:187]
    ds_read2_b32 v[102:103], v14 offset0:114 offset1:115
    v_mfma_f32_16x16x32_bf16 v[180:183], v[68:71], v[124:127], v[180:183]
    ds_read_b128 v[168:171], v7 offset:2496
    v_mfma_f32_16x16x32_bf16 v[184:187], v[68:71], v[128:131], v[184:187]
    ds_read2_b32 v[104:105], v14 offset0:240 offset1:241
    v_mfma_f32_16x16x32_bf16 v[184:187], v[72:75], v[124:127], v[184:187]
    ds_read2_b32 v[106:107], v14 offset0:242 offset1:243
    s_waitcnt lgkmcnt(0)
    s_add_u32 s63, s67, 81920
    buffer_load_dwordx4 v[40:43], v9, s[36:39], s63 offen
    v_mfma_f32_16x16x32_bf16 v[172:175], v[76:79], v[140:143], v[172:175]
    v_mfma_f32_16x16x32_bf16 v[176:179], v[76:79], v[144:147], v[176:179]
    v_mfma_f32_16x16x32_bf16 v[180:183], v[76:79], v[148:151], v[180:183]
    v_mfma_f32_16x16x32_bf16 v[184:187], v[76:79], v[152:155], v[184:187]
    v_mfma_f32_16x16x32_bf16 v[176:179], v[80:83], v[140:143], v[176:179]
    v_mfma_f32_16x16x32_bf16 v[180:183], v[80:83], v[144:147], v[180:183]
    v_mfma_f32_16x16x32_bf16 v[184:187], v[80:83], v[148:151], v[184:187]
    v_mfma_f32_16x16x32_bf16 v[180:183], v[84:87], v[140:143], v[180:183]
    v_mfma_f32_16x16x32_bf16 v[184:187], v[84:87], v[144:147], v[184:187]
    v_mfma_f32_16x16x32_bf16 v[184:187], v[88:91], v[140:143], v[184:187]
    v_mfma_f32_16x16x32_bf16 v[172:175], v[92:95], v[156:159], v[172:175]
    v_mfma_f32_16x16x32_bf16 v[176:179], v[92:95], v[160:163], v[176:179]
    v_mfma_f32_16x16x32_bf16 v[180:183], v[92:95], v[164:167], v[180:183]
    v_mfma_f32_16x16x32_bf16 v[184:187], v[92:95], v[168:171], v[184:187]
    v_mfma_f32_16x16x32_bf16 v[176:179], v[96:99], v[156:159], v[176:179]
    v_mfma_f32_16x16x32_bf16 v[180:183], v[96:99], v[160:163], v[180:183]
    v_mfma_f32_16x16x32_bf16 v[184:187], v[96:99], v[164:167], v[184:187]
    v_mfma_f32_16x16x32_bf16 v[180:183], v[100:103], v[156:159], v[180:183]
    v_mfma_f32_16x16x32_bf16 v[184:187], v[100:103], v[160:163], v[184:187]
    v_mfma_f32_16x16x32_bf16 v[184:187], v[104:107], v[156:159], v[184:187]
    s_waitcnt vmcnt(0)
loj_42:
    s_nop 3
    v_cvt_pk_bf16_f32 v172, v172, v173
    v_cvt_pk_bf16_f32 v173, v174, v175
    ds_write_b64 v8, v[172:173] offset:16896
    v_cvt_pk_bf16_f32 v176, v176, v177
    v_cvt_pk_bf16_f32 v177, v178, v179
    ds_write_b64 v8, v[176:177] offset:17408
    v_cvt_pk_bf16_f32 v180, v180, v181
    v_cvt_pk_bf16_f32 v181, v182, v183
    ds_write_b64 v8, v[180:181] offset:17920
    v_cvt_pk_bf16_f32 v184, v184, v185
    v_cvt_pk_bf16_f32 v185, v186, v187
    ds_write_b64 v8, v[184:185] offset:18432
    s_waitcnt lgkmcnt(0)
    s_barrier
    ds_read_b64_tr_b16 v[188:189], v12 offset:16896
    ds_read_b64_tr_b16 v[190:191], v12 offset:25344
    ds_read_b64_tr_b16 v[192:193], v12 offset:17024
    ds_read_b64_tr_b16 v[194:195], v12 offset:25472
    s_waitcnt vmcnt(2) lgkmcnt(0)
    v_lshlrev_b32 v196, 16, v188
    v_and_b32 v197, 0xffff0000, v188
    v_lshlrev_b32 v198, 16, v36
    v_and_b32 v199, 0xffff0000, v36
    v_mul_f32 v196, v196, v198
    v_mul_f32 v197, v197, v199
    v_cvt_pk_bf16_f32 v188, v196, v197
    v_lshlrev_b32 v200, 16, v189
    v_and_b32 v201, 0xffff0000, v189
    v_lshlrev_b32 v202, 16, v37
    v_and_b32 v203, 0xffff0000, v37
    v_mul_f32 v200, v200, v202
    v_mul_f32 v201, v201, v203
    v_cvt_pk_bf16_f32 v189, v200, v201
    v_lshlrev_b32 v196, 16, v190
    v_and_b32 v197, 0xffff0000, v190
    v_lshlrev_b32 v198, 16, v38
    v_and_b32 v199, 0xffff0000, v38
    v_mul_f32 v196, v196, v198
    v_mul_f32 v197, v197, v199
    v_cvt_pk_bf16_f32 v190, v196, v197
    v_lshlrev_b32 v200, 16, v191
    v_and_b32 v201, 0xffff0000, v191
    v_lshlrev_b32 v202, 16, v39
    v_and_b32 v203, 0xffff0000, v39
    v_mul_f32 v200, v200, v202
    v_mul_f32 v201, v201, v203
    v_cvt_pk_bf16_f32 v191, v200, v201
    s_add_u32 s63, s64, 0
    buffer_store_dwordx4 v[188:191], v11, s[40:43], s63 offen
    v_lshlrev_b32 v196, 16, v192
    v_and_b32 v197, 0xffff0000, v192
    v_lshlrev_b32 v198, 16, v40
    v_and_b32 v199, 0xffff0000, v40
    v_mul_f32 v196, v196, v198
    v_mul_f32 v197, v197, v199
    v_cvt_pk_bf16_f32 v192, v196, v197
    v_lshlrev_b32 v200, 16, v193
    v_and_b32 v201, 0xffff0000, v193
    v_lshlrev_b32 v202, 16, v41
    v_and_b32 v203, 0xffff0000, v41
    v_mul_f32 v200, v200, v202
    v_mul_f32 v201, v201, v203
    v_cvt_pk_bf16_f32 v193, v200, v201
    v_lshlrev_b32 v196, 16, v194
    v_and_b32 v197, 0xffff0000, v194
    v_lshlrev_b32 v198, 16, v42
    v_and_b32 v199, 0xffff0000, v42
    v_mul_f32 v196, v196, v198
    v_mul_f32 v197, v197, v199
    v_cvt_pk_bf16_f32 v194, v196, v197
    v_lshlrev_b32 v200, 16, v195
    v_and_b32 v201, 0xffff0000, v195
    v_lshlrev_b32 v202, 16, v43
    v_and_b32 v203, 0xffff0000, v43
    v_mul_f32 v200, v200, v202
    v_mul_f32 v201, v201, v203
    v_cvt_pk_bf16_f32 v195, v200, v201
    s_add_u32 s63, s64, 163840
    buffer_store_dwordx4 v[192:195], v11, s[40:43], s63 offen
    s_branch L_FIN
L_BC:
    s_lshr_b32 s60, s3, 1
    s_and_b32 s61, s3, 1
    s_mov_b32 s63, 0x3fb8aa3b
    s_mov_b32 s66, s63
    s_mov_b32 s67, s63
    s_mov_b32 s64, 0x358637bd
    v_and_b32 v2, 15, v1
    v_lshrrev_b32 v3, 4, v1
    s_lshl_b32 s62, s3, 12
    v_lshrrev_b32 v4, 1, v2
    v_xor_b32 v4, v4, v3
    v_lshlrev_b32 v4, 4, v4
    v_lshl_add_u32 v4, v2, 7, v4
    v_add_u32 v7, s62, v4
    v_xor_b32 v8, 64, v7
    v_xor_b32 v22, 0x1000, v7
    v_xor_b32 v23, 0x1000, v8
    v_lshrrev_b32 v4, 2, v2
    v_lshl_add_u32 v4, v3, 3, v4
    v_mul_u32_u24 v4, 320, v4
    v_add_u32 v4, 49152, v4
    v_and_b32 v5, 1, v3
    v_lshlrev_b32 v5, 5, v5
    s_mul_i32 s62, s61, 160
    v_and_b32 v6, 3, v2
    v_lshl_add_u32 v9, v6, 3, s62
    v_add_u32 v9, 0, v9
    v_xor_b32 v9, v9, v5
    v_add_u32 v9, v9, v4
    v_lshl_add_u32 v10, v6, 3, s62
    v_add_u32 v10, 40, v10
    v_xor_b32 v10, v10, v5
    v_add_u32 v10, v10, v4
    v_lshl_add_u32 v11, v6, 3, s62
    v_add_u32 v11, 80, v11
    v_xor_b32 v11, v11, v5
    v_add_u32 v11, v11, v4
    v_lshl_add_u32 v12, v6, 3, s62
    v_add_u32 v12, 120, v12
    v_xor_b32 v12, v12, v5
    v_add_u32 v12, v12, v4
    v_mul_u32_u24 v13, 40, v6
    v_add_u32 v13, s62, v13
    v_add_u32 v13, 32, v13
    v_xor_b32 v13, v13, v5
    v_add_u32 v13, v13, v4
    v_lshrrev_b32 v4, 1, v3
    v_mul_u32_u24 v4, 2688, v4
    v_and_b32 v5, 1, v3
    v_mul_u32_u24 v5, 1408, v5
    v_add3_u32 v4, v4, v5, 32
    v_lshrrev_b32 v5, 2, v2
    v_mul_u32_u24 v5, 160, v5
    v_add_u32 v4, v4, v5
    v_add_u32 v4, 110560, v4
    v_lshl_add_u32 v20, v6, 3, v4
    v_mul_u32_u24 v5, 40, v6
    v_add3_u32 v21, v4, v5, 32
    v_mov_b32 v4, s64
    v_cmp_gt_u32 vcc, 8, v2
    s_mul_i32 s62, s60, 9216
    s_mul_i32 s65, s61, 4480
    s_add_u32 s62, s62, s65
    s_add_u32 s62, s62, 142848
    v_cndmask_b32 v148, 0, v4, vcc
    v_cndmask_b32 v149, 0, v4, vcc
    v_cndmask_b32 v150, 0, v4, vcc
    v_cndmask_b32 v151, 0, v4, vcc
    v_mov_b32 v132, s64
    v_mov_b32 v133, s64
    v_mov_b32 v134, s64
    v_mov_b32 v135, s64
    v_mov_b32 v136, s64
    v_mov_b32 v137, s64
    v_mov_b32 v138, s64
    v_mov_b32 v139, s64
    v_cndmask_b32 v168, 0, v4, vcc
    v_cndmask_b32 v169, 0, v4, vcc
    v_cndmask_b32 v170, 0, v4, vcc
    v_cndmask_b32 v171, 0, v4, vcc
    v_mov_b32 v152, s64
    v_mov_b32 v153, s64
    v_mov_b32 v154, s64
    v_mov_b32 v155, s64
    v_mov_b32 v156, s64
    v_mov_b32 v157, s64
    v_mov_b32 v158, s64
    v_mov_b32 v159, s64
    v_cndmask_b32 v188, 0, v4, vcc
    v_cndmask_b32 v189, 0, v4, vcc
    v_cndmask_b32 v190, 0, v4, vcc
    v_cndmask_b32 v191, 0, v4, vcc
    v_mov_b32 v172, s64
    v_mov_b32 v173, s64
    v_mov_b32 v174, s64
    v_mov_b32 v175, s64
    v_mov_b32 v176, s64
    v_mov_b32 v177, s64
    v_mov_b32 v178, s64
    v_mov_b32 v179, s64
    v_cndmask_b32 v208, 0, v4, vcc
    v_cndmask_b32 v209, 0, v4, vcc
    v_cndmask_b32 v210, 0, v4, vcc
    v_cndmask_b32 v211, 0, v4, vcc
    v_mov_b32 v192, s64
    v_mov_b32 v193, s64
    v_mov_b32 v194, s64
    v_mov_b32 v195, s64
    v_mov_b32 v196, s64
    v_mov_b32 v197, s64
    v_mov_b32 v198, s64
    v_mov_b32 v199, s64
    v_mov_b32 v212, s64
    v_mov_b32 v213, s64
    v_mov_b32 v214, s64
    v_mov_b32 v215, s64
    v_mov_b32 v216, s64
    v_mov_b32 v217, s64
    v_mov_b32 v218, s64
    v_mov_b32 v219, s64
    v_mov_b32 v220, s64
    v_mov_b32 v221, s64
    v_mov_b32 v222, s64
    v_mov_b32 v223, s64
    v_mov_b32 v224, s64
    v_mov_b32 v225, s64
    v_mov_b32 v226, s64
    v_mov_b32 v227, s64
    v_mov_b32 v228, s64
    v_mov_b32 v229, s64
    v_mov_b32 v230, s64
    v_mov_b32 v231, s64
    v_mov_b32 v232, s64
    v_mov_b32 v233, s64
    v_mov_b32 v234, s64
    v_mov_b32 v235, s64
    v_mov_b32 v236, s64
    v_mov_b32 v237, s64
    v_mov_b32 v238, s64
    v_mov_b32 v239, s64
    v_mov_b32 v240, s64
    v_mov_b32 v241, s64
    v_mov_b32 v242, s64
    v_mov_b32 v243, s64
    v_mov_b32 v244, s64
    v_mov_b32 v245, s64
    v_mov_b32 v246, s64
    v_mov_b32 v247, s64
    v_mov_b32 v248, s64
    v_mov_b32 v249, s64
    v_mov_b32 v250, s64
    v_mov_b32 v251, s64
    v_mov_b32 v40, 1.0
    v_mov_b32 v41, 0
    v_mov_b32 v42, 0
    v_mov_b32 v43, 0
    v_mov_b32 v44, 0
    v_mov_b32 v45, 0
    v_mov_b32 v46, 0
    v_mov_b32 v47, 0
    v_min_u32 v4, 143, v0
    v_lshlrev_b32 v4, 6, v4
    v_add_u32 v4, 142896, v4
    ds_write_b128 v4, v[40:43]
    ds_write_b128 v4, v[44:47] offset:9216
    v_cmp_eq_u32 vcc, 0, v2
    v_add_u32 v4, 8, v2
    v_add_u32 v5, 4, v2
    v_cndmask_b32 v4, v4, 20, vcc
    v_cndmask_b32 v5, v5, 20, vcc
    v_mad_u32_u24 v14, v2, 5, v3
    v_mul_u32_u24 v6, 171, v14
    v_lshrrev_b32 v6, 9, v6
    v_add_u32 v14, v14, v6
    v_lshl_add_u32 v14, v14, 4, s62
    v_mad_u32_u24 v15, v2, 5, 4
    v_mul_u32_u24 v6, 171, v15
    v_lshrrev_b32 v6, 9, v6
    v_add_u32 v15, v15, v6
    v_lshl_add_u32 v15, v15, 4, s62
    v_mad_u32_u24 v16, v4, 5, v3
    v_mul_u32_u24 v6, 171, v16
    v_lshrrev_b32 v6, 9, v6
    v_add_u32 v16, v16, v6
    v_lshl_add_u32 v16, v16, 4, s62
    v_mad_u32_u24 v17, v4, 5, 4
    v_mul_u32_u24 v6, 171, v17
    v_lshrrev_b32 v6, 9, v6
    v_add_u32 v17, v17, v6
    v_lshl_add_u32 v17, v17, 4, s62
    v_mad_u32_u24 v18, v5, 5, v3
    v_mul_u32_u24 v6, 171, v18
    v_lshrrev_b32 v6, 9, v6
    v_add_u32 v18, v18, v6
    v_lshl_add_u32 v18, v18, 4, s62
    v_mad_u32_u24 v19, v5, 5, 4
    v_mul_u32_u24 v6, 171, v19
    v_lshrrev_b32 v6, 9, v6
    v_add_u32 v19, v19, v6
    v_lshl_add_u32 v19, v19, 4, s62
    v_lshlrev_b32 v27, 2, v0
    v_add_u32 v28, 4096, v27
    v_add_u32 v29, 8192, v27
    v_add_u32 v30, 142848, v27
    v_lshlrev_b32 v31, 4, v1
    v_and_b32 v4, 31, v1
    v_lshlrev_b32 v5, 2, v2
    s_mov_b32 s62, 0x54325410
    v_lshrrev_b32 v5, v5, s62
    v_and_b32 v5, 15, v5
    v_add_u32 v5, 16, v5
    v_cmp_lt_u32 vcc, 23, v4
    s_mov_b32 s62, 114688
    s_nop 0
    v_cndmask_b32 v5, v5, 21, vcc
    v_cmp_gt_u32 vcc, 16, v4
    v_lshrrev_b32 v6, 5, v1
    s_nop 0
    v_cndmask_b32 v5, v5, v4, vcc
    v_mad_u32_u24 v5, v5, 40, s62
    v_lshl_add_u32 v24, v6, 4, v5
    v_add_u32 v5, 32, v5
    v_cmp_eq_u32 vcc, 0, v6
    v_mov_b32 v4, 115528
    s_nop 0
    v_cndmask_b32 v25, v4, v5, vcc
    v_cndmask_b32 v26, v5, v4, vcc
    s_mul_i32 s62, s3, 880
    s_add_u32 s62, s62, 114688
    v_and_b32 v4, 3, v1
    v_lshl_add_u32 v4, v4, 3, s62
    v_lshrrev_b32 v5, 2, v1
    v_mad_u32_u24 v32, v5, 24, v4
    s_mul_i32 s62, s53, 8960
    s_add_u32 s62, s62, 5242880
    s_waitcnt lgkmcnt(0)
    s_add_u32 s40, s30, s62
    s_addc_u32 s41, s31, 0
    s_mov_b32 s42, 8960
    s_mov_b32 s43, 0x20000
    s_mul_i32 s65, s3, 2240
    s_add_u32 s62, s62, s65
    s_add_u32 s32, s30, s62
    s_addc_u32 s33, s31, 0
    s_mov_b32 s34, 2240
    s_mov_b32 s35, 0x20000
    s_add_u32 s36, s30, 2621440
    s_addc_u32 s37, s31, 0
    s_mov_b32 s38, 2621440
    s_mov_b32 s39, 0x20000
    s_add_u32 s48, s30, 5316608
    s_addc_u32 s49, s31, 0
    s_mov_b32 s50, 131072
    s_mov_b32 s51, 0x20000
    s_barrier
    ds_read_b128 v[40:43], v7 offset:16384
    ds_read_b128 v[44:47], v7 offset:18432
    ds_read_b128 v[48:51], v22 offset:16384
    ds_read_b128 v[52:55], v22 offset:18432
    ds_read_b64_tr_b16 v[72:73], v9 offset:0
    ds_read_b64_tr_b16 v[74:75], v9 offset:1280
    ds_read_b64_tr_b16 v[76:77], v10 offset:0
    ds_read_b64_tr_b16 v[78:79], v10 offset:1280
    ds_read_b64_tr_b16 v[80:81], v11 offset:0
    ds_read_b64_tr_b16 v[82:83], v11 offset:1280
    ds_read_b64_tr_b16 v[112:113], v20 offset:21504
    ds_read_b64_tr_b16 v[114:115], v20 offset:22144
    ds_read_b64_tr_b16 v[116:117], v20 offset:21544
    ds_read_b64_tr_b16 v[118:119], v20 offset:22184
    ds_read_b64_tr_b16 v[120:121], v20 offset:21584
    ds_read_b64_tr_b16 v[122:123], v20 offset:22224
    ds_read_b64_tr_b16 v[124:125], v20 offset:21624
    ds_read_b64_tr_b16 v[126:127], v20 offset:22264
    ds_read_b64_tr_b16 v[128:129], v21 offset:21504
    ds_read_b64_tr_b16 v[130:131], v21 offset:22144
    ds_read_b64_tr_b16 v[84:85], v12 offset:0
    ds_read_b64_tr_b16 v[86:87], v12 offset:1280
    ds_read_b64_tr_b16 v[88:89], v13 offset:0
    ds_read_b64_tr_b16 v[90:91], v13 offset:1280
    s_waitcnt lgkmcnt(0)
    v_mfma_f32_16x16x32_bf16 v[212:215], v[112:115], v[40:43], v[212:215]
    ds_read_b128 v[56:59], v8 offset:16384
    v_mfma_f32_16x16x32_bf16 v[232:235], v[112:115], v[44:47], v[232:235]
    ds_read_b128 v[60:63], v8 offset:18432
    v_mfma_f32_16x16x32_bf16 v[216:219], v[116:119], v[40:43], v[216:219]
    ds_read_b128 v[64:67], v23 offset:16384
    v_mfma_f32_16x16x32_bf16 v[236:239], v[116:119], v[44:47], v[236:239]
    ds_read_b128 v[68:71], v23 offset:18432
    v_mfma_f32_16x16x32_bf16 v[220:223], v[120:123], v[40:43], v[220:223]
    ds_read_b64_tr_b16 v[92:93], v9 offset:10240
    v_mfma_f32_16x16x32_bf16 v[240:243], v[120:123], v[44:47], v[240:243]
    ds_read_b64_tr_b16 v[94:95], v9 offset:11520
    v_mfma_f32_16x16x32_bf16 v[224:227], v[124:127], v[40:43], v[224:227]
    ds_read_b64_tr_b16 v[96:97], v10 offset:10240
    v_mfma_f32_16x16x32_bf16 v[244:247], v[124:127], v[44:47], v[244:247]
    ds_read_b64_tr_b16 v[98:99], v10 offset:11520
    v_mfma_f32_16x16x32_bf16 v[228:231], v[128:131], v[40:43], v[228:231]
    ds_read_b64_tr_b16 v[100:101], v11 offset:10240
    v_mfma_f32_16x16x32_bf16 v[248:251], v[128:131], v[44:47], v[248:251]
    ds_read_b64_tr_b16 v[102:103], v11 offset:11520
    v_mfma_f32_16x16x32_bf16 v[132:135], v[40:43], v[72:75], v[132:135]
    ds_read_b64_tr_b16 v[112:113], v20 offset:26880
    v_mfma_f32_16x16x32_bf16 v[136:139], v[40:43], v[76:79], v[136:139]
    ds_read_b64_tr_b16 v[114:115], v20 offset:27520
    v_mfma_f32_16x16x32_bf16 v[140:143], v[40:43], v[80:83], 0
    ds_read_b64_tr_b16 v[116:117], v20 offset:26920
    v_mfma_f32_16x16x32_bf16 v[144:147], v[40:43], v[84:87], 0
    ds_read_b64_tr_b16 v[118:119], v20 offset:27560
    v_mfma_f32_16x16x32_bf16 v[148:151], v[40:43], v[88:91], v[148:151]
    ds_read_b64_tr_b16 v[120:121], v20 offset:26960
    v_mfma_f32_16x16x32_bf16 v[152:155], v[44:47], v[72:75], v[152:155]
    ds_read_b64_tr_b16 v[122:123], v20 offset:27600
    v_mfma_f32_16x16x32_bf16 v[156:159], v[44:47], v[76:79], v[156:159]
    ds_read_b64_tr_b16 v[124:125], v20 offset:27000
    v_mfma_f32_16x16x32_bf16 v[160:163], v[44:47], v[80:83], 0
    ds_read_b64_tr_b16 v[126:127], v20 offset:27640
    v_mfma_f32_16x16x32_bf16 v[164:167], v[44:47], v[84:87], 0
    ds_read_b64_tr_b16 v[128:129], v21 offset:26880
    v_mfma_f32_16x16x32_bf16 v[168:171], v[44:47], v[88:91], v[168:171]
    ds_read_b64_tr_b16 v[130:131], v21 offset:27520
    v_mfma_f32_16x16x32_bf16 v[172:175], v[48:51], v[72:75], v[172:175]
    ds_read_b64_tr_b16 v[104:105], v12 offset:10240
    v_mfma_f32_16x16x32_bf16 v[176:179], v[48:51], v[76:79], v[176:179]
    ds_read_b64_tr_b16 v[106:107], v12 offset:11520
    v_mfma_f32_16x16x32_bf16 v[180:183], v[48:51], v[80:83], 0
    ds_read_b64_tr_b16 v[108:109], v13 offset:10240
    v_mfma_f32_16x16x32_bf16 v[184:187], v[48:51], v[84:87], 0
    ds_read_b64_tr_b16 v[110:111], v13 offset:11520
    v_mfma_f32_16x16x32_bf16 v[188:191], v[48:51], v[88:91], v[188:191]
    v_mfma_f32_16x16x32_bf16 v[192:195], v[52:55], v[72:75], v[192:195]
    v_mfma_f32_16x16x32_bf16 v[196:199], v[52:55], v[76:79], v[196:199]
    v_mfma_f32_16x16x32_bf16 v[200:203], v[52:55], v[80:83], 0
    v_mfma_f32_16x16x32_bf16 v[204:207], v[52:55], v[84:87], 0
    v_mfma_f32_16x16x32_bf16 v[208:211], v[52:55], v[88:91], v[208:211]
    s_waitcnt lgkmcnt(0)
    s_barrier
    v_mfma_f32_16x16x32_bf16 v[212:215], v[112:115], v[56:59], v[212:215]
    ds_read_b128 v[40:43], v7 offset:32768
    v_mfma_f32_16x16x32_bf16 v[232:235], v[112:115], v[60:63], v[232:235]
    ds_read_b128 v[44:47], v7 offset:34816
    v_mfma_f32_16x16x32_bf16 v[216:219], v[116:119], v[56:59], v[216:219]
    ds_read_b128 v[48:51], v22 offset:32768
    v_mfma_f32_16x16x32_bf16 v[236:239], v[116:119], v[60:63], v[236:239]
    ds_read_b128 v[52:55], v22 offset:34816
    v_mfma_f32_16x16x32_bf16 v[220:223], v[120:123], v[56:59], v[220:223]
    ds_read_b64_tr_b16 v[72:73], v9 offset:20480
    v_mfma_f32_16x16x32_bf16 v[240:243], v[120:123], v[60:63], v[240:243]
    ds_read_b64_tr_b16 v[74:75], v9 offset:21760
    v_mfma_f32_16x16x32_bf16 v[224:227], v[124:127], v[56:59], v[224:227]
    ds_read_b64_tr_b16 v[76:77], v10 offset:20480
    v_mfma_f32_16x16x32_bf16 v[244:247], v[124:127], v[60:63], v[244:247]
    ds_read_b64_tr_b16 v[78:79], v10 offset:21760
    v_mfma_f32_16x16x32_bf16 v[228:231], v[128:131], v[56:59], v[228:231]
    ds_read_b64_tr_b16 v[80:81], v11 offset:20480
    v_mfma_f32_16x16x32_bf16 v[248:251], v[128:131], v[60:63], v[248:251]
    ds_read_b64_tr_b16 v[82:83], v11 offset:21760
    v_mfma_f32_16x16x32_bf16 v[132:135], v[56:59], v[92:95], v[132:135]
    ds_read_b64_tr_b16 v[112:113], v20 offset:0
    v_mfma_f32_16x16x32_bf16 v[136:139], v[56:59], v[96:99], v[136:139]
    ds_read_b64_tr_b16 v[114:115], v20 offset:640
    v_mfma_f32_16x16x32_bf16 v[140:143], v[56:59], v[100:103], v[140:143]
    ds_read_b64_tr_b16 v[116:117], v20 offset:40
    v_mfma_f32_16x16x32_bf16 v[144:147], v[56:59], v[104:107], v[144:147]
    ds_read_b64_tr_b16 v[118:119], v20 offset:680
    v_mfma_f32_16x16x32_bf16 v[148:151], v[56:59], v[108:111], v[148:151]
    ds_read_b64_tr_b16 v[120:121], v20 offset:80
    v_mfma_f32_16x16x32_bf16 v[152:155], v[60:63], v[92:95], v[152:155]
    ds_read_b64_tr_b16 v[122:123], v20 offset:720
    v_mfma_f32_16x16x32_bf16 v[156:159], v[60:63], v[96:99], v[156:159]
    ds_read_b64_tr_b16 v[124:125], v20 offset:120
    v_mfma_f32_16x16x32_bf16 v[160:163], v[60:63], v[100:103], v[160:163]
    ds_read_b64_tr_b16 v[126:127], v20 offset:760
    v_mfma_f32_16x16x32_bf16 v[164:167], v[60:63], v[104:107], v[164:167]
    ds_read_b64_tr_b16 v[128:129], v21 offset:0
    v_mfma_f32_16x16x32_bf16 v[168:171], v[60:63], v[108:111], v[168:171]
    ds_read_b64_tr_b16 v[130:131], v21 offset:640
    v_mfma_f32_16x16x32_bf16 v[172:175], v[64:67], v[92:95], v[172:175]
    ds_read_b64_tr_b16 v[84:85], v12 offset:20480
    v_mfma_f32_16x16x32_bf16 v[176:179], v[64:67], v[96:99], v[176:179]
    ds_read_b64_tr_b16 v[86:87], v12 offset:21760
    v_mfma_f32_16x16x32_bf16 v[180:183], v[64:67], v[100:103], v[180:183]
    ds_read_b64_tr_b16 v[88:89], v13 offset:20480
    v_mfma_f32_16x16x32_bf16 v[184:187], v[64:67], v[104:107], v[184:187]
    ds_read_b64_tr_b16 v[90:91], v13 offset:21760
    v_mfma_f32_16x16x32_bf16 v[188:191], v[64:67], v[108:111], v[188:191]
    v_mfma_f32_16x16x32_bf16 v[192:195], v[68:71], v[92:95], v[192:195]
    v_mfma_f32_16x16x32_bf16 v[196:199], v[68:71], v[96:99], v[196:199]
    v_mfma_f32_16x16x32_bf16 v[200:203], v[68:71], v[100:103], v[200:203]
    v_mfma_f32_16x16x32_bf16 v[204:207], v[68:71], v[104:107], v[204:207]
    v_mfma_f32_16x16x32_bf16 v[208:211], v[68:71], v[108:111], v[208:211]
    s_waitcnt lgkmcnt(0)
    v_mfma_f32_16x16x32_bf16 v[212:215], v[112:115], v[40:43], v[212:215]
    ds_read_b128 v[56:59], v8 offset:32768
    v_mfma_f32_16x16x32_bf16 v[232:235], v[112:115], v[44:47], v[232:235]
    ds_read_b128 v[60:63], v8 offset:34816
    v_mfma_f32_16x16x32_bf16 v[216:219], v[116:119], v[40:43], v[216:219]
    ds_read_b128 v[64:67], v23 offset:32768
    v_mfma_f32_16x16x32_bf16 v[236:239], v[116:119], v[44:47], v[236:239]
    ds_read_b128 v[68:71], v23 offset:34816
    v_mfma_f32_16x16x32_bf16 v[220:223], v[120:123], v[40:43], v[220:223]
    ds_read_b64_tr_b16 v[92:93], v9 offset:30720
    v_mfma_f32_16x16x32_bf16 v[240:243], v[120:123], v[44:47], v[240:243]
    ds_read_b64_tr_b16 v[94:95], v9 offset:32000
    v_mfma_f32_16x16x32_bf16 v[224:227], v[124:127], v[40:43], v[224:227]
    ds_read_b64_tr_b16 v[96:97], v10 offset:30720
    v_mfma_f32_16x16x32_bf16 v[244:247], v[124:127], v[44:47], v[244:247]
    ds_read_b64_tr_b16 v[98:99], v10 offset:32000
    v_mfma_f32_16x16x32_bf16 v[228:231], v[128:131], v[40:43], v[228:231]
    ds_read_b64_tr_b16 v[100:101], v11 offset:30720
    v_mfma_f32_16x16x32_bf16 v[248:251], v[128:131], v[44:47], v[248:251]
    ds_read_b64_tr_b16 v[102:103], v11 offset:32000
    v_mfma_f32_16x16x32_bf16 v[132:135], v[40:43], v[72:75], v[132:135]
    ds_read_b64_tr_b16 v[112:113], v20 offset:5376
    v_mfma_f32_16x16x32_bf16 v[136:139], v[40:43], v[76:79], v[136:139]
    ds_read_b64_tr_b16 v[114:115], v20 offset:6016
    v_mfma_f32_16x16x32_bf16 v[140:143], v[40:43], v[80:83], v[140:143]
    ds_read_b64_tr_b16 v[116:117], v20 offset:5416
    v_mfma_f32_16x16x32_bf16 v[144:147], v[40:43], v[84:87], v[144:147]
    ds_read_b64_tr_b16 v[118:119], v20 offset:6056
    v_mfma_f32_16x16x32_bf16 v[148:151], v[40:43], v[88:91], v[148:151]
    ds_read_b64_tr_b16 v[120:121], v20 offset:5456
    v_mfma_f32_16x16x32_bf16 v[152:155], v[44:47], v[72:75], v[152:155]
    ds_read_b64_tr_b16 v[122:123], v20 offset:6096
    v_mfma_f32_16x16x32_bf16 v[156:159], v[44:47], v[76:79], v[156:159]
    ds_read_b64_tr_b16 v[124:125], v20 offset:5496
    v_mfma_f32_16x16x32_bf16 v[160:163], v[44:47], v[80:83], v[160:163]
    ds_read_b64_tr_b16 v[126:127], v20 offset:6136
    v_mfma_f32_16x16x32_bf16 v[164:167], v[44:47], v[84:87], v[164:167]
    ds_read_b64_tr_b16 v[128:129], v21 offset:5376
    v_mfma_f32_16x16x32_bf16 v[168:171], v[44:47], v[88:91], v[168:171]
    ds_read_b64_tr_b16 v[130:131], v21 offset:6016
    v_mfma_f32_16x16x32_bf16 v[172:175], v[48:51], v[72:75], v[172:175]
    ds_read_b64_tr_b16 v[104:105], v12 offset:30720
    v_mfma_f32_16x16x32_bf16 v[176:179], v[48:51], v[76:79], v[176:179]
    ds_read_b64_tr_b16 v[106:107], v12 offset:32000
    v_mfma_f32_16x16x32_bf16 v[180:183], v[48:51], v[80:83], v[180:183]
    ds_read_b64_tr_b16 v[108:109], v13 offset:30720
    v_mfma_f32_16x16x32_bf16 v[184:187], v[48:51], v[84:87], v[184:187]
    ds_read_b64_tr_b16 v[110:111], v13 offset:32000
    v_mfma_f32_16x16x32_bf16 v[188:191], v[48:51], v[88:91], v[188:191]
    v_mfma_f32_16x16x32_bf16 v[192:195], v[52:55], v[72:75], v[192:195]
    v_mfma_f32_16x16x32_bf16 v[196:199], v[52:55], v[76:79], v[196:199]
    v_mfma_f32_16x16x32_bf16 v[200:203], v[52:55], v[80:83], v[200:203]
    v_mfma_f32_16x16x32_bf16 v[204:207], v[52:55], v[84:87], v[204:207]
    v_mfma_f32_16x16x32_bf16 v[208:211], v[52:55], v[88:91], v[208:211]
    s_waitcnt lgkmcnt(0)
    s_barrier
    v_mfma_f32_16x16x32_bf16 v[212:215], v[112:115], v[56:59], v[212:215]
    ds_read_b128 v[40:43], v7 offset:0
    v_mfma_f32_16x16x32_bf16 v[232:235], v[112:115], v[60:63], v[232:235]
    ds_read_b128 v[44:47], v7 offset:2048
    v_mfma_f32_16x16x32_bf16 v[216:219], v[116:119], v[56:59], v[216:219]
    ds_read_b128 v[48:51], v22 offset:0
    v_mfma_f32_16x16x32_bf16 v[236:239], v[116:119], v[60:63], v[236:239]
    ds_read_b128 v[52:55], v22 offset:2048
    v_mfma_f32_16x16x32_bf16 v[220:223], v[120:123], v[56:59], v[220:223]
    ds_read_b64_tr_b16 v[72:73], v9 offset:40960
    v_mfma_f32_16x16x32_bf16 v[240:243], v[120:123], v[60:63], v[240:243]
    ds_read_b64_tr_b16 v[74:75], v9 offset:42240
    v_mfma_f32_16x16x32_bf16 v[224:227], v[124:127], v[56:59], v[224:227]
    ds_read_b64_tr_b16 v[76:77], v10 offset:40960
    v_mfma_f32_16x16x32_bf16 v[244:247], v[124:127], v[60:63], v[244:247]
    ds_read_b64_tr_b16 v[78:79], v10 offset:42240
    v_mfma_f32_16x16x32_bf16 v[228:231], v[128:131], v[56:59], v[228:231]
    ds_read_b64_tr_b16 v[80:81], v11 offset:40960
    v_mfma_f32_16x16x32_bf16 v[248:251], v[128:131], v[60:63], v[248:251]
    ds_read_b64_tr_b16 v[82:83], v11 offset:42240
    v_mfma_f32_16x16x32_bf16 v[132:135], v[56:59], v[92:95], v[132:135]
    ds_read_b64_tr_b16 v[112:113], v20 offset:10752
    v_mfma_f32_16x16x32_bf16 v[136:139], v[56:59], v[96:99], v[136:139]
    ds_read_b64_tr_b16 v[114:115], v20 offset:11392
    v_mfma_f32_16x16x32_bf16 v[140:143], v[56:59], v[100:103], v[140:143]
    ds_read_b64_tr_b16 v[116:117], v20 offset:10792
    v_mfma_f32_16x16x32_bf16 v[144:147], v[56:59], v[104:107], v[144:147]
    ds_read_b64_tr_b16 v[118:119], v20 offset:11432
    v_mfma_f32_16x16x32_bf16 v[148:151], v[56:59], v[108:111], v[148:151]
    ds_read_b64_tr_b16 v[120:121], v20 offset:10832
    v_mfma_f32_16x16x32_bf16 v[152:155], v[60:63], v[92:95], v[152:155]
    ds_read_b64_tr_b16 v[122:123], v20 offset:11472
    v_mfma_f32_16x16x32_bf16 v[156:159], v[60:63], v[96:99], v[156:159]
    ds_read_b64_tr_b16 v[124:125], v20 offset:10872
    v_mfma_f32_16x16x32_bf16 v[160:163], v[60:63], v[100:103], v[160:163]
    ds_read_b64_tr_b16 v[126:127], v20 offset:11512
    v_mfma_f32_16x16x32_bf16 v[164:167], v[60:63], v[104:107], v[164:167]
    ds_read_b64_tr_b16 v[128:129], v21 offset:10752
    v_mfma_f32_16x16x32_bf16 v[168:171], v[60:63], v[108:111], v[168:171]
    ds_read_b64_tr_b16 v[130:131], v21 offset:11392
    v_mfma_f32_16x16x32_bf16 v[172:175], v[64:67], v[92:95], v[172:175]
    ds_read_b64_tr_b16 v[84:85], v12 offset:40960
    v_mfma_f32_16x16x32_bf16 v[176:179], v[64:67], v[96:99], v[176:179]
    ds_read_b64_tr_b16 v[86:87], v12 offset:42240
    v_mfma_f32_16x16x32_bf16 v[180:183], v[64:67], v[100:103], v[180:183]
    ds_read_b64_tr_b16 v[88:89], v13 offset:40960
    v_mfma_f32_16x16x32_bf16 v[184:187], v[64:67], v[104:107], v[184:187]
    ds_read_b64_tr_b16 v[90:91], v13 offset:42240
    v_mfma_f32_16x16x32_bf16 v[188:191], v[64:67], v[108:111], v[188:191]
    v_mfma_f32_16x16x32_bf16 v[192:195], v[68:71], v[92:95], v[192:195]
    v_mfma_f32_16x16x32_bf16 v[196:199], v[68:71], v[96:99], v[196:199]
    v_mfma_f32_16x16x32_bf16 v[200:203], v[68:71], v[100:103], v[200:203]
    v_mfma_f32_16x16x32_bf16 v[204:207], v[68:71], v[104:107], v[204:207]
    v_mfma_f32_16x16x32_bf16 v[208:211], v[68:71], v[108:111], v[208:211]
    s_waitcnt lgkmcnt(0)
    v_mfma_f32_16x16x32_bf16 v[212:215], v[112:115], v[40:43], v[212:215]
    ds_read_b128 v[56:59], v8 offset:0
    v_mfma_f32_16x16x32_bf16 v[232:235], v[112:115], v[44:47], v[232:235]
    ds_read_b128 v[60:63], v8 offset:2048
    v_mfma_f32_16x16x32_bf16 v[216:219], v[116:119], v[40:43], v[216:219]
    ds_read_b128 v[64:67], v23 offset:0
    v_mfma_f32_16x16x32_bf16 v[236:239], v[116:119], v[44:47], v[236:239]
    ds_read_b128 v[68:71], v23 offset:2048
    v_mfma_f32_16x16x32_bf16 v[220:223], v[120:123], v[40:43], v[220:223]
    ds_read_b64_tr_b16 v[92:93], v9 offset:51200
    v_mfma_f32_16x16x32_bf16 v[240:243], v[120:123], v[44:47], v[240:243]
    ds_read_b64_tr_b16 v[94:95], v9 offset:52480
    v_mfma_f32_16x16x32_bf16 v[224:227], v[124:127], v[40:43], v[224:227]
    ds_read_b64_tr_b16 v[96:97], v10 offset:51200
    v_mfma_f32_16x16x32_bf16 v[244:247], v[124:127], v[44:47], v[244:247]
    ds_read_b64_tr_b16 v[98:99], v10 offset:52480
    v_mfma_f32_16x16x32_bf16 v[228:231], v[128:131], v[40:43], v[228:231]
    ds_read_b64_tr_b16 v[100:101], v11 offset:51200
    v_mfma_f32_16x16x32_bf16 v[248:251], v[128:131], v[44:47], v[248:251]
    ds_read_b64_tr_b16 v[102:103], v11 offset:52480
    v_mfma_f32_16x16x32_bf16 v[132:135], v[40:43], v[72:75], v[132:135]
    ds_read_b64_tr_b16 v[112:113], v20 offset:16128
    v_mfma_f32_16x16x32_bf16 v[136:139], v[40:43], v[76:79], v[136:139]
    ds_read_b64_tr_b16 v[114:115], v20 offset:16768
    v_mfma_f32_16x16x32_bf16 v[140:143], v[40:43], v[80:83], v[140:143]
    ds_read_b64_tr_b16 v[116:117], v20 offset:16168
    v_mfma_f32_16x16x32_bf16 v[144:147], v[40:43], v[84:87], v[144:147]
    ds_read_b64_tr_b16 v[118:119], v20 offset:16808
    v_mfma_f32_16x16x32_bf16 v[148:151], v[40:43], v[88:91], v[148:151]
    ds_read_b64_tr_b16 v[120:121], v20 offset:16208
    v_mfma_f32_16x16x32_bf16 v[152:155], v[44:47], v[72:75], v[152:155]
    ds_read_b64_tr_b16 v[122:123], v20 offset:16848
    v_mfma_f32_16x16x32_bf16 v[156:159], v[44:47], v[76:79], v[156:159]
    ds_read_b64_tr_b16 v[124:125], v20 offset:16248
    v_mfma_f32_16x16x32_bf16 v[160:163], v[44:47], v[80:83], v[160:163]
    ds_read_b64_tr_b16 v[126:127], v20 offset:16888
    v_mfma_f32_16x16x32_bf16 v[164:167], v[44:47], v[84:87], v[164:167]
    ds_read_b64_tr_b16 v[128:129], v21 offset:16128
    v_mfma_f32_16x16x32_bf16 v[168:171], v[44:47], v[88:91], v[168:171]
    ds_read_b64_tr_b16 v[130:131], v21 offset:16768
    v_mfma_f32_16x16x32_bf16 v[172:175], v[48:51], v[72:75], v[172:175]
    ds_read_b64_tr_b16 v[104:105], v12 offset:51200
    v_mfma_f32_16x16x32_bf16 v[176:179], v[48:51], v[76:79], v[176:179]
    ds_read_b64_tr_b16 v[106:107], v12 offset:52480
    v_mfma_f32_16x16x32_bf16 v[180:183], v[48:51], v[80:83], v[180:183]
    ds_read_b64_tr_b16 v[108:109], v13 offset:51200
    v_mfma_f32_16x16x32_bf16 v[184:187], v[48:51], v[84:87], v[184:187]
    ds_read_b64_tr_b16 v[110:111], v13 offset:52480
    v_mfma_f32_16x16x32_bf16 v[188:191], v[48:51], v[88:91], v[188:191]
    v_mfma_f32_16x16x32_bf16 v[192:195], v[52:55], v[72:75], v[192:195]
    v_mfma_f32_16x16x32_bf16 v[196:199], v[52:55], v[76:79], v[196:199]
    v_mfma_f32_16x16x32_bf16 v[200:203], v[52:55], v[80:83], v[200:203]
    v_mfma_f32_16x16x32_bf16 v[204:207], v[52:55], v[84:87], v[204:207]
    v_mfma_f32_16x16x32_bf16 v[208:211], v[52:55], v[88:91], v[208:211]
    s_waitcnt lgkmcnt(0)
    s_barrier
    v_mfma_f32_16x16x32_bf16 v[212:215], v[112:115], v[56:59], v[212:215]
    ds_read_b128 v[40:43], v7 offset:16384
    v_mfma_f32_16x16x32_bf16 v[232:235], v[112:115], v[60:63], v[232:235]
    ds_read_b128 v[44:47], v7 offset:18432
    v_mfma_f32_16x16x32_bf16 v[216:219], v[116:119], v[56:59], v[216:219]
    ds_read_b128 v[48:51], v22 offset:16384
    v_mfma_f32_16x16x32_bf16 v[236:239], v[116:119], v[60:63], v[236:239]
    ds_read_b128 v[52:55], v22 offset:18432
    v_mfma_f32_16x16x32_bf16 v[220:223], v[120:123], v[56:59], v[220:223]
    ds_read_b64_tr_b16 v[72:73], v9 offset:0
    v_mfma_f32_16x16x32_bf16 v[240:243], v[120:123], v[60:63], v[240:243]
    ds_read_b64_tr_b16 v[74:75], v9 offset:1280
    v_mfma_f32_16x16x32_bf16 v[224:227], v[124:127], v[56:59], v[224:227]
    ds_read_b64_tr_b16 v[76:77], v10 offset:0
    v_mfma_f32_16x16x32_bf16 v[244:247], v[124:127], v[60:63], v[244:247]
    ds_read_b64_tr_b16 v[78:79], v10 offset:1280
    v_mfma_f32_16x16x32_bf16 v[228:231], v[128:131], v[56:59], v[228:231]
    ds_read_b64_tr_b16 v[80:81], v11 offset:0
    v_mfma_f32_16x16x32_bf16 v[248:251], v[128:131], v[60:63], v[248:251]
    ds_read_b64_tr_b16 v[82:83], v11 offset:1280
    v_mfma_f32_16x16x32_bf16 v[132:135], v[56:59], v[92:95], v[132:135]
    ds_read_b64_tr_b16 v[112:113], v20 offset:21504
    v_mfma_f32_16x16x32_bf16 v[136:139], v[56:59], v[96:99], v[136:139]
    ds_read_b64_tr_b16 v[114:115], v20 offset:22144
    v_mfma_f32_16x16x32_bf16 v[140:143], v[56:59], v[100:103], v[140:143]
    ds_read_b64_tr_b16 v[116:117], v20 offset:21544
    v_mfma_f32_16x16x32_bf16 v[144:147], v[56:59], v[104:107], v[144:147]
    ds_read_b64_tr_b16 v[118:119], v20 offset:22184
    v_mfma_f32_16x16x32_bf16 v[148:151], v[56:59], v[108:111], v[148:151]
    ds_read_b64_tr_b16 v[120:121], v20 offset:21584
    v_mfma_f32_16x16x32_bf16 v[152:155], v[60:63], v[92:95], v[152:155]
    ds_read_b64_tr_b16 v[122:123], v20 offset:22224
    v_mfma_f32_16x16x32_bf16 v[156:159], v[60:63], v[96:99], v[156:159]
    ds_read_b64_tr_b16 v[124:125], v20 offset:21624
    v_mfma_f32_16x16x32_bf16 v[160:163], v[60:63], v[100:103], v[160:163]
    ds_read_b64_tr_b16 v[126:127], v20 offset:22264
    v_mfma_f32_16x16x32_bf16 v[164:167], v[60:63], v[104:107], v[164:167]
    ds_read_b64_tr_b16 v[128:129], v21 offset:21504
    v_mfma_f32_16x16x32_bf16 v[168:171], v[60:63], v[108:111], v[168:171]
    ds_read_b64_tr_b16 v[130:131], v21 offset:22144
    v_mfma_f32_16x16x32_bf16 v[172:175], v[64:67], v[92:95], v[172:175]
    ds_read_b64_tr_b16 v[84:85], v12 offset:0
    v_mfma_f32_16x16x32_bf16 v[176:179], v[64:67], v[96:99], v[176:179]
    ds_read_b64_tr_b16 v[86:87], v12 offset:1280
    v_mfma_f32_16x16x32_bf16 v[180:183], v[64:67], v[100:103], v[180:183]
    ds_read_b64_tr_b16 v[88:89], v13 offset:0
    v_mfma_f32_16x16x32_bf16 v[184:187], v[64:67], v[104:107], v[184:187]
    ds_read_b64_tr_b16 v[90:91], v13 offset:1280
    v_mfma_f32_16x16x32_bf16 v[188:191], v[64:67], v[108:111], v[188:191]
    v_mfma_f32_16x16x32_bf16 v[192:195], v[68:71], v[92:95], v[192:195]
    v_mfma_f32_16x16x32_bf16 v[196:199], v[68:71], v[96:99], v[196:199]
    v_mfma_f32_16x16x32_bf16 v[200:203], v[68:71], v[100:103], v[200:203]
    v_mfma_f32_16x16x32_bf16 v[204:207], v[68:71], v[104:107], v[204:207]
    v_mfma_f32_16x16x32_bf16 v[208:211], v[68:71], v[108:111], v[208:211]
    s_waitcnt lgkmcnt(0)
    v_mfma_f32_16x16x32_bf16 v[212:215], v[112:115], v[40:43], v[212:215]
    ds_read_b128 v[56:59], v8 offset:16384
    v_mfma_f32_16x16x32_bf16 v[232:235], v[112:115], v[44:47], v[232:235]
    ds_read_b128 v[60:63], v8 offset:18432
    v_mfma_f32_16x16x32_bf16 v[216:219], v[116:119], v[40:43], v[216:219]
    ds_read_b128 v[64:67], v23 offset:16384
    v_mfma_f32_16x16x32_bf16 v[236:239], v[116:119], v[44:47], v[236:239]
    ds_read_b128 v[68:71], v23 offset:18432
    v_mfma_f32_16x16x32_bf16 v[220:223], v[120:123], v[40:43], v[220:223]
    ds_read_b64_tr_b16 v[92:93], v9 offset:10240
    v_mfma_f32_16x16x32_bf16 v[240:243], v[120:123], v[44:47], v[240:243]
    ds_read_b64_tr_b16 v[94:95], v9 offset:11520
    v_mfma_f32_16x16x32_bf16 v[224:227], v[124:127], v[40:43], v[224:227]
    ds_read_b64_tr_b16 v[96:97], v10 offset:10240
    v_mfma_f32_16x16x32_bf16 v[244:247], v[124:127], v[44:47], v[244:247]
    ds_read_b64_tr_b16 v[98:99], v10 offset:11520
    v_mfma_f32_16x16x32_bf16 v[228:231], v[128:131], v[40:43], v[228:231]
    ds_read_b64_tr_b16 v[100:101], v11 offset:10240
    v_mfma_f32_16x16x32_bf16 v[248:251], v[128:131], v[44:47], v[248:251]
    ds_read_b64_tr_b16 v[102:103], v11 offset:11520
    v_mfma_f32_16x16x32_bf16 v[132:135], v[40:43], v[72:75], v[132:135]
    ds_read_b64_tr_b16 v[112:113], v20 offset:26880
    v_mfma_f32_16x16x32_bf16 v[136:139], v[40:43], v[76:79], v[136:139]
    ds_read_b64_tr_b16 v[114:115], v20 offset:27520
    v_mfma_f32_16x16x32_bf16 v[140:143], v[40:43], v[80:83], v[140:143]
    ds_read_b64_tr_b16 v[116:117], v20 offset:26920
    v_mfma_f32_16x16x32_bf16 v[144:147], v[40:43], v[84:87], v[144:147]
    ds_read_b64_tr_b16 v[118:119], v20 offset:27560
    v_mfma_f32_16x16x32_bf16 v[148:151], v[40:43], v[88:91], v[148:151]
    ds_read_b64_tr_b16 v[120:121], v20 offset:26960
    v_mfma_f32_16x16x32_bf16 v[152:155], v[44:47], v[72:75], v[152:155]
    ds_read_b64_tr_b16 v[122:123], v20 offset:27600
    v_mfma_f32_16x16x32_bf16 v[156:159], v[44:47], v[76:79], v[156:159]
    ds_read_b64_tr_b16 v[124:125], v20 offset:27000
    v_mfma_f32_16x16x32_bf16 v[160:163], v[44:47], v[80:83], v[160:163]
    ds_read_b64_tr_b16 v[126:127], v20 offset:27640
    v_mfma_f32_16x16x32_bf16 v[164:167], v[44:47], v[84:87], v[164:167]
    ds_read_b64_tr_b16 v[128:129], v21 offset:26880
    v_mfma_f32_16x16x32_bf16 v[168:171], v[44:47], v[88:91], v[168:171]
    ds_read_b64_tr_b16 v[130:131], v21 offset:27520
    v_mfma_f32_16x16x32_bf16 v[172:175], v[48:51], v[72:75], v[172:175]
    ds_read_b64_tr_b16 v[104:105], v12 offset:10240
    v_mfma_f32_16x16x32_bf16 v[176:179], v[48:51], v[76:79], v[176:179]
    ds_read_b64_tr_b16 v[106:107], v12 offset:11520
    v_mfma_f32_16x16x32_bf16 v[180:183], v[48:51], v[80:83], v[180:183]
    ds_read_b64_tr_b16 v[108:109], v13 offset:10240
    v_mfma_f32_16x16x32_bf16 v[184:187], v[48:51], v[84:87], v[184:187]
    ds_read_b64_tr_b16 v[110:111], v13 offset:11520
    v_mfma_f32_16x16x32_bf16 v[188:191], v[48:51], v[88:91], v[188:191]
    v_mfma_f32_16x16x32_bf16 v[192:195], v[52:55], v[72:75], v[192:195]
    v_mfma_f32_16x16x32_bf16 v[196:199], v[52:55], v[76:79], v[196:199]
    v_mfma_f32_16x16x32_bf16 v[200:203], v[52:55], v[80:83], v[200:203]
    v_mfma_f32_16x16x32_bf16 v[204:207], v[52:55], v[84:87], v[204:207]
    v_mfma_f32_16x16x32_bf16 v[208:211], v[52:55], v[88:91], v[208:211]
    s_waitcnt lgkmcnt(0)
    s_barrier
    v_mfma_f32_16x16x32_bf16 v[212:215], v[112:115], v[56:59], v[212:215]
    ds_read_b128 v[40:43], v7 offset:32768
    v_mfma_f32_16x16x32_bf16 v[232:235], v[112:115], v[60:63], v[232:235]
    ds_read_b128 v[44:47], v7 offset:34816
    v_mfma_f32_16x16x32_bf16 v[216:219], v[116:119], v[56:59], v[216:219]
    ds_read_b128 v[48:51], v22 offset:32768
    v_mfma_f32_16x16x32_bf16 v[236:239], v[116:119], v[60:63], v[236:239]
    ds_read_b128 v[52:55], v22 offset:34816
    v_mfma_f32_16x16x32_bf16 v[220:223], v[120:123], v[56:59], v[220:223]
    ds_read_b64_tr_b16 v[72:73], v9 offset:20480
    v_mfma_f32_16x16x32_bf16 v[240:243], v[120:123], v[60:63], v[240:243]
    ds_read_b64_tr_b16 v[74:75], v9 offset:21760
    v_mfma_f32_16x16x32_bf16 v[224:227], v[124:127], v[56:59], v[224:227]
    ds_read_b64_tr_b16 v[76:77], v10 offset:20480
    v_mfma_f32_16x16x32_bf16 v[244:247], v[124:127], v[60:63], v[244:247]
    ds_read_b64_tr_b16 v[78:79], v10 offset:21760
    v_mfma_f32_16x16x32_bf16 v[228:231], v[128:131], v[56:59], v[228:231]
    ds_read_b64_tr_b16 v[80:81], v11 offset:20480
    v_mfma_f32_16x16x32_bf16 v[248:251], v[128:131], v[60:63], v[248:251]
    ds_read_b64_tr_b16 v[82:83], v11 offset:21760
    v_mfma_f32_16x16x32_bf16 v[132:135], v[56:59], v[92:95], v[132:135]
    ds_read_b64_tr_b16 v[112:113], v20 offset:0
    v_mfma_f32_16x16x32_bf16 v[136:139], v[56:59], v[96:99], v[136:139]
    ds_read_b64_tr_b16 v[114:115], v20 offset:640
    v_mfma_f32_16x16x32_bf16 v[140:143], v[56:59], v[100:103], v[140:143]
    ds_read_b64_tr_b16 v[116:117], v20 offset:40
    v_mfma_f32_16x16x32_bf16 v[144:147], v[56:59], v[104:107], v[144:147]
    ds_read_b64_tr_b16 v[118:119], v20 offset:680
    v_mfma_f32_16x16x32_bf16 v[148:151], v[56:59], v[108:111], v[148:151]
    ds_read_b64_tr_b16 v[120:121], v20 offset:80
    v_mfma_f32_16x16x32_bf16 v[152:155], v[60:63], v[92:95], v[152:155]
    ds_read_b64_tr_b16 v[122:123], v20 offset:720
    v_mfma_f32_16x16x32_bf16 v[156:159], v[60:63], v[96:99], v[156:159]
    ds_read_b64_tr_b16 v[124:125], v20 offset:120
    v_mfma_f32_16x16x32_bf16 v[160:163], v[60:63], v[100:103], v[160:163]
    ds_read_b64_tr_b16 v[126:127], v20 offset:760
    v_mfma_f32_16x16x32_bf16 v[164:167], v[60:63], v[104:107], v[164:167]
    ds_read_b64_tr_b16 v[128:129], v21 offset:0
    v_mfma_f32_16x16x32_bf16 v[168:171], v[60:63], v[108:111], v[168:171]
    ds_read_b64_tr_b16 v[130:131], v21 offset:640
    v_mfma_f32_16x16x32_bf16 v[172:175], v[64:67], v[92:95], v[172:175]
    ds_read_b64_tr_b16 v[84:85], v12 offset:20480
    v_mfma_f32_16x16x32_bf16 v[176:179], v[64:67], v[96:99], v[176:179]
    ds_read_b64_tr_b16 v[86:87], v12 offset:21760
    v_mfma_f32_16x16x32_bf16 v[180:183], v[64:67], v[100:103], v[180:183]
    ds_read_b64_tr_b16 v[88:89], v13 offset:20480
    v_mfma_f32_16x16x32_bf16 v[184:187], v[64:67], v[104:107], v[184:187]
    ds_read_b64_tr_b16 v[90:91], v13 offset:21760
    v_mfma_f32_16x16x32_bf16 v[188:191], v[64:67], v[108:111], v[188:191]
    v_mfma_f32_16x16x32_bf16 v[192:195], v[68:71], v[92:95], v[192:195]
    v_mfma_f32_16x16x32_bf16 v[196:199], v[68:71], v[96:99], v[196:199]
    v_mfma_f32_16x16x32_bf16 v[200:203], v[68:71], v[100:103], v[200:203]
    v_mfma_f32_16x16x32_bf16 v[204:207], v[68:71], v[104:107], v[204:207]
    v_mfma_f32_16x16x32_bf16 v[208:211], v[68:71], v[108:111], v[208:211]
    s_waitcnt lgkmcnt(0)
    v_mfma_f32_16x16x32_bf16 v[212:215], v[112:115], v[40:43], v[212:215]
    ds_read_b128 v[56:59], v8 offset:32768
    v_mfma_f32_16x16x32_bf16 v[232:235], v[112:115], v[44:47], v[232:235]
    ds_read_b128 v[60:63], v8 offset:34816
    v_mfma_f32_16x16x32_bf16 v[216:219], v[116:119], v[40:43], v[216:219]
    ds_read_b128 v[64:67], v23 offset:32768
    v_mfma_f32_16x16x32_bf16 v[236:239], v[116:119], v[44:47], v[236:239]
    ds_read_b128 v[68:71], v23 offset:34816
    v_mfma_f32_16x16x32_bf16 v[220:223], v[120:123], v[40:43], v[220:223]
    ds_read_b64_tr_b16 v[92:93], v9 offset:30720
    v_mfma_f32_16x16x32_bf16 v[240:243], v[120:123], v[44:47], v[240:243]
    ds_read_b64_tr_b16 v[94:95], v9 offset:32000
    v_mfma_f32_16x16x32_bf16 v[224:227], v[124:127], v[40:43], v[224:227]
    ds_read_b64_tr_b16 v[96:97], v10 offset:30720
    v_mfma_f32_16x16x32_bf16 v[244:247], v[124:127], v[44:47], v[244:247]
    ds_read_b64_tr_b16 v[98:99], v10 offset:32000
    v_mfma_f32_16x16x32_bf16 v[228:231], v[128:131], v[40:43], v[228:231]
    ds_read_b64_tr_b16 v[100:101], v11 offset:30720
    v_mfma_f32_16x16x32_bf16 v[248:251], v[128:131], v[44:47], v[248:251]
    ds_read_b64_tr_b16 v[102:103], v11 offset:32000
    v_mfma_f32_16x16x32_bf16 v[132:135], v[40:43], v[72:75], v[132:135]
    ds_read_b64_tr_b16 v[112:113], v20 offset:5376
    v_mfma_f32_16x16x32_bf16 v[136:139], v[40:43], v[76:79], v[136:139]
    ds_read_b64_tr_b16 v[114:115], v20 offset:6016
    v_mfma_f32_16x16x32_bf16 v[140:143], v[40:43], v[80:83], v[140:143]
    ds_read_b64_tr_b16 v[116:117], v20 offset:5416
    v_mfma_f32_16x16x32_bf16 v[144:147], v[40:43], v[84:87], v[144:147]
    ds_read_b64_tr_b16 v[118:119], v20 offset:6056
    v_mfma_f32_16x16x32_bf16 v[148:151], v[40:43], v[88:91], v[148:151]
    ds_read_b64_tr_b16 v[120:121], v20 offset:5456
    v_mfma_f32_16x16x32_bf16 v[152:155], v[44:47], v[72:75], v[152:155]
    ds_read_b64_tr_b16 v[122:123], v20 offset:6096
    v_mfma_f32_16x16x32_bf16 v[156:159], v[44:47], v[76:79], v[156:159]
    ds_read_b64_tr_b16 v[124:125], v20 offset:5496
    v_mfma_f32_16x16x32_bf16 v[160:163], v[44:47], v[80:83], v[160:163]
    ds_read_b64_tr_b16 v[126:127], v20 offset:6136
    v_mfma_f32_16x16x32_bf16 v[164:167], v[44:47], v[84:87], v[164:167]
    ds_read_b64_tr_b16 v[128:129], v21 offset:5376
    v_mfma_f32_16x16x32_bf16 v[168:171], v[44:47], v[88:91], v[168:171]
    ds_read_b64_tr_b16 v[130:131], v21 offset:6016
    v_mfma_f32_16x16x32_bf16 v[172:175], v[48:51], v[72:75], v[172:175]
    ds_read_b64_tr_b16 v[104:105], v12 offset:30720
    v_mfma_f32_16x16x32_bf16 v[176:179], v[48:51], v[76:79], v[176:179]
    ds_read_b64_tr_b16 v[106:107], v12 offset:32000
    v_mfma_f32_16x16x32_bf16 v[180:183], v[48:51], v[80:83], v[180:183]
    ds_read_b64_tr_b16 v[108:109], v13 offset:30720
    v_mfma_f32_16x16x32_bf16 v[184:187], v[48:51], v[84:87], v[184:187]
    ds_read_b64_tr_b16 v[110:111], v13 offset:32000
    v_mfma_f32_16x16x32_bf16 v[188:191], v[48:51], v[88:91], v[188:191]
    v_mfma_f32_16x16x32_bf16 v[192:195], v[52:55], v[72:75], v[192:195]
    v_mfma_f32_16x16x32_bf16 v[196:199], v[52:55], v[76:79], v[196:199]
    v_mfma_f32_16x16x32_bf16 v[200:203], v[52:55], v[80:83], v[200:203]
    v_mfma_f32_16x16x32_bf16 v[204:207], v[52:55], v[84:87], v[204:207]
    v_mfma_f32_16x16x32_bf16 v[208:211], v[52:55], v[88:91], v[208:211]
    s_waitcnt lgkmcnt(0)
    s_barrier
    v_mfma_f32_16x16x32_bf16 v[212:215], v[112:115], v[56:59], v[212:215]
    ds_read_b128 v[40:43], v7 offset:0
    v_mfma_f32_16x16x32_bf16 v[232:235], v[112:115], v[60:63], v[232:235]
    ds_read_b128 v[44:47], v7 offset:2048
    v_mfma_f32_16x16x32_bf16 v[216:219], v[116:119], v[56:59], v[216:219]
    ds_read_b128 v[48:51], v22 offset:0
    v_mfma_f32_16x16x32_bf16 v[236:239], v[116:119], v[60:63], v[236:239]
    ds_read_b128 v[52:55], v22 offset:2048
    v_mfma_f32_16x16x32_bf16 v[220:223], v[120:123], v[56:59], v[220:223]
    ds_read_b64_tr_b16 v[72:73], v9 offset:40960
    v_mfma_f32_16x16x32_bf16 v[240:243], v[120:123], v[60:63], v[240:243]
    ds_read_b64_tr_b16 v[74:75], v9 offset:42240
    v_mfma_f32_16x16x32_bf16 v[224:227], v[124:127], v[56:59], v[224:227]
    ds_read_b64_tr_b16 v[76:77], v10 offset:40960
    v_mfma_f32_16x16x32_bf16 v[244:247], v[124:127], v[60:63], v[244:247]
    ds_read_b64_tr_b16 v[78:79], v10 offset:42240
    v_mfma_f32_16x16x32_bf16 v[228:231], v[128:131], v[56:59], v[228:231]
    ds_read_b64_tr_b16 v[80:81], v11 offset:40960
    v_mfma_f32_16x16x32_bf16 v[248:251], v[128:131], v[60:63], v[248:251]
    ds_read_b64_tr_b16 v[82:83], v11 offset:42240
    v_mfma_f32_16x16x32_bf16 v[132:135], v[56:59], v[92:95], v[132:135]
    ds_read_b64_tr_b16 v[112:113], v20 offset:10752
    v_mfma_f32_16x16x32_bf16 v[136:139], v[56:59], v[96:99], v[136:139]
    ds_read_b64_tr_b16 v[114:115], v20 offset:11392
    v_mfma_f32_16x16x32_bf16 v[140:143], v[56:59], v[100:103], v[140:143]
    ds_read_b64_tr_b16 v[116:117], v20 offset:10792
    v_mfma_f32_16x16x32_bf16 v[144:147], v[56:59], v[104:107], v[144:147]
    ds_read_b64_tr_b16 v[118:119], v20 offset:11432
    v_mfma_f32_16x16x32_bf16 v[148:151], v[56:59], v[108:111], v[148:151]
    ds_read_b64_tr_b16 v[120:121], v20 offset:10832
    v_mfma_f32_16x16x32_bf16 v[152:155], v[60:63], v[92:95], v[152:155]
    ds_read_b64_tr_b16 v[122:123], v20 offset:11472
    v_mfma_f32_16x16x32_bf16 v[156:159], v[60:63], v[96:99], v[156:159]
    ds_read_b64_tr_b16 v[124:125], v20 offset:10872
    v_mfma_f32_16x16x32_bf16 v[160:163], v[60:63], v[100:103], v[160:163]
    ds_read_b64_tr_b16 v[126:127], v20 offset:11512
    v_mfma_f32_16x16x32_bf16 v[164:167], v[60:63], v[104:107], v[164:167]
    ds_read_b64_tr_b16 v[128:129], v21 offset:10752
    v_mfma_f32_16x16x32_bf16 v[168:171], v[60:63], v[108:111], v[168:171]
    ds_read_b64_tr_b16 v[130:131], v21 offset:11392
    v_mfma_f32_16x16x32_bf16 v[172:175], v[64:67], v[92:95], v[172:175]
    ds_read_b64_tr_b16 v[84:85], v12 offset:40960
    v_mfma_f32_16x16x32_bf16 v[176:179], v[64:67], v[96:99], v[176:179]
    ds_read_b64_tr_b16 v[86:87], v12 offset:42240
    v_mfma_f32_16x16x32_bf16 v[180:183], v[64:67], v[100:103], v[180:183]
    ds_read_b64_tr_b16 v[88:89], v13 offset:40960
    v_mfma_f32_16x16x32_bf16 v[184:187], v[64:67], v[104:107], v[184:187]
    ds_read_b64_tr_b16 v[90:91], v13 offset:42240
    v_mfma_f32_16x16x32_bf16 v[188:191], v[64:67], v[108:111], v[188:191]
    v_mfma_f32_16x16x32_bf16 v[192:195], v[68:71], v[92:95], v[192:195]
    v_mfma_f32_16x16x32_bf16 v[196:199], v[68:71], v[96:99], v[196:199]
    v_mfma_f32_16x16x32_bf16 v[200:203], v[68:71], v[100:103], v[200:203]
    v_mfma_f32_16x16x32_bf16 v[204:207], v[68:71], v[104:107], v[204:207]
    v_mfma_f32_16x16x32_bf16 v[208:211], v[68:71], v[108:111], v[208:211]
    s_waitcnt lgkmcnt(0)
    v_mfma_f32_16x16x32_bf16 v[212:215], v[112:115], v[40:43], v[212:215]
    ds_read_b128 v[56:59], v8 offset:0
    v_mfma_f32_16x16x32_bf16 v[232:235], v[112:115], v[44:47], v[232:235]
    ds_read_b128 v[60:63], v8 offset:2048
    v_mfma_f32_16x16x32_bf16 v[216:219], v[116:119], v[40:43], v[216:219]
    ds_read_b128 v[64:67], v23 offset:0
    v_mfma_f32_16x16x32_bf16 v[236:239], v[116:119], v[44:47], v[236:239]
    ds_read_b128 v[68:71], v23 offset:2048
    v_mfma_f32_16x16x32_bf16 v[220:223], v[120:123], v[40:43], v[220:223]
    ds_read_b64_tr_b16 v[92:93], v9 offset:51200
    v_mfma_f32_16x16x32_bf16 v[240:243], v[120:123], v[44:47], v[240:243]
    ds_read_b64_tr_b16 v[94:95], v9 offset:52480
    v_mfma_f32_16x16x32_bf16 v[224:227], v[124:127], v[40:43], v[224:227]
    ds_read_b64_tr_b16 v[96:97], v10 offset:51200
    v_mfma_f32_16x16x32_bf16 v[244:247], v[124:127], v[44:47], v[244:247]
    ds_read_b64_tr_b16 v[98:99], v10 offset:52480
    v_mfma_f32_16x16x32_bf16 v[228:231], v[128:131], v[40:43], v[228:231]
    ds_read_b64_tr_b16 v[100:101], v11 offset:51200
    v_mfma_f32_16x16x32_bf16 v[248:251], v[128:131], v[44:47], v[248:251]
    ds_read_b64_tr_b16 v[102:103], v11 offset:52480
    v_mfma_f32_16x16x32_bf16 v[132:135], v[40:43], v[72:75], v[132:135]
    ds_read_b64_tr_b16 v[112:113], v20 offset:16128
    v_mfma_f32_16x16x32_bf16 v[136:139], v[40:43], v[76:79], v[136:139]
    ds_read_b64_tr_b16 v[114:115], v20 offset:16768
    v_mfma_f32_16x16x32_bf16 v[140:143], v[40:43], v[80:83], v[140:143]
    ds_read_b64_tr_b16 v[116:117], v20 offset:16168
    v_mfma_f32_16x16x32_bf16 v[144:147], v[40:43], v[84:87], v[144:147]
    ds_read_b64_tr_b16 v[118:119], v20 offset:16808
    v_mfma_f32_16x16x32_bf16 v[148:151], v[40:43], v[88:91], v[148:151]
    ds_read_b64_tr_b16 v[120:121], v20 offset:16208
    v_mfma_f32_16x16x32_bf16 v[152:155], v[44:47], v[72:75], v[152:155]
    ds_read_b64_tr_b16 v[122:123], v20 offset:16848
    v_mfma_f32_16x16x32_bf16 v[156:159], v[44:47], v[76:79], v[156:159]
    ds_read_b64_tr_b16 v[124:125], v20 offset:16248
    v_mfma_f32_16x16x32_bf16 v[160:163], v[44:47], v[80:83], v[160:163]
    ds_read_b64_tr_b16 v[126:127], v20 offset:16888
    v_mfma_f32_16x16x32_bf16 v[164:167], v[44:47], v[84:87], v[164:167]
    ds_read_b64_tr_b16 v[128:129], v21 offset:16128
    v_mfma_f32_16x16x32_bf16 v[168:171], v[44:47], v[88:91], v[168:171]
    ds_read_b64_tr_b16 v[130:131], v21 offset:16768
    v_mfma_f32_16x16x32_bf16 v[172:175], v[48:51], v[72:75], v[172:175]
    ds_read_b64_tr_b16 v[104:105], v12 offset:51200
    v_mfma_f32_16x16x32_bf16 v[176:179], v[48:51], v[76:79], v[176:179]
    ds_read_b64_tr_b16 v[106:107], v12 offset:52480
    v_mfma_f32_16x16x32_bf16 v[180:183], v[48:51], v[80:83], v[180:183]
    ds_read_b64_tr_b16 v[108:109], v13 offset:51200
    v_mfma_f32_16x16x32_bf16 v[184:187], v[48:51], v[84:87], v[184:187]
    ds_read_b64_tr_b16 v[110:111], v13 offset:52480
    v_mfma_f32_16x16x32_bf16 v[188:191], v[48:51], v[88:91], v[188:191]
    v_mfma_f32_16x16x32_bf16 v[192:195], v[52:55], v[72:75], v[192:195]
    v_mfma_f32_16x16x32_bf16 v[196:199], v[52:55], v[76:79], v[196:199]
    v_mfma_f32_16x16x32_bf16 v[200:203], v[52:55], v[80:83], v[200:203]
    v_mfma_f32_16x16x32_bf16 v[204:207], v[52:55], v[84:87], v[204:207]
    v_mfma_f32_16x16x32_bf16 v[208:211], v[52:55], v[88:91], v[208:211]
    s_waitcnt lgkmcnt(0)
    s_barrier
    v_mfma_f32_16x16x32_bf16 v[212:215], v[112:115], v[56:59], v[212:215]
    ds_read_b128 v[40:43], v7 offset:16384
    v_mfma_f32_16x16x32_bf16 v[232:235], v[112:115], v[60:63], v[232:235]
    ds_read_b128 v[44:47], v7 offset:18432
    v_mfma_f32_16x16x32_bf16 v[216:219], v[116:119], v[56:59], v[216:219]
    ds_read_b128 v[48:51], v22 offset:16384
    v_mfma_f32_16x16x32_bf16 v[236:239], v[116:119], v[60:63], v[236:239]
    ds_read_b128 v[52:55], v22 offset:18432
    v_mfma_f32_16x16x32_bf16 v[220:223], v[120:123], v[56:59], v[220:223]
    ds_read_b64_tr_b16 v[72:73], v9 offset:0
    v_mfma_f32_16x16x32_bf16 v[240:243], v[120:123], v[60:63], v[240:243]
    ds_read_b64_tr_b16 v[74:75], v9 offset:1280
    v_mfma_f32_16x16x32_bf16 v[224:227], v[124:127], v[56:59], v[224:227]
    ds_read_b64_tr_b16 v[76:77], v10 offset:0
    v_mfma_f32_16x16x32_bf16 v[244:247], v[124:127], v[60:63], v[244:247]
    ds_read_b64_tr_b16 v[78:79], v10 offset:1280
    v_mfma_f32_16x16x32_bf16 v[228:231], v[128:131], v[56:59], v[228:231]
    ds_read_b64_tr_b16 v[80:81], v11 offset:0
    v_mfma_f32_16x16x32_bf16 v[248:251], v[128:131], v[60:63], v[248:251]
    ds_read_b64_tr_b16 v[82:83], v11 offset:1280
    v_mfma_f32_16x16x32_bf16 v[132:135], v[56:59], v[92:95], v[132:135]
    ds_read_b64_tr_b16 v[112:113], v20 offset:21504
    v_mfma_f32_16x16x32_bf16 v[136:139], v[56:59], v[96:99], v[136:139]
    ds_read_b64_tr_b16 v[114:115], v20 offset:22144
    v_mfma_f32_16x16x32_bf16 v[140:143], v[56:59], v[100:103], v[140:143]
    ds_read_b64_tr_b16 v[116:117], v20 offset:21544
    v_mfma_f32_16x16x32_bf16 v[144:147], v[56:59], v[104:107], v[144:147]
    ds_read_b64_tr_b16 v[118:119], v20 offset:22184
    v_mfma_f32_16x16x32_bf16 v[148:151], v[56:59], v[108:111], v[148:151]
    ds_read_b64_tr_b16 v[120:121], v20 offset:21584
    v_mfma_f32_16x16x32_bf16 v[152:155], v[60:63], v[92:95], v[152:155]
    ds_read_b64_tr_b16 v[122:123], v20 offset:22224
    v_mfma_f32_16x16x32_bf16 v[156:159], v[60:63], v[96:99], v[156:159]
    ds_read_b64_tr_b16 v[124:125], v20 offset:21624
    v_mfma_f32_16x16x32_bf16 v[160:163], v[60:63], v[100:103], v[160:163]
    ds_read_b64_tr_b16 v[126:127], v20 offset:22264
    v_mfma_f32_16x16x32_bf16 v[164:167], v[60:63], v[104:107], v[164:167]
    ds_read_b64_tr_b16 v[128:129], v21 offset:21504
    v_mfma_f32_16x16x32_bf16 v[168:171], v[60:63], v[108:111], v[168:171]
    ds_read_b64_tr_b16 v[130:131], v21 offset:22144
    v_mfma_f32_16x16x32_bf16 v[172:175], v[64:67], v[92:95], v[172:175]
    ds_read_b64_tr_b16 v[84:85], v12 offset:0
    v_mfma_f32_16x16x32_bf16 v[176:179], v[64:67], v[96:99], v[176:179]
    ds_read_b64_tr_b16 v[86:87], v12 offset:1280
    v_mfma_f32_16x16x32_bf16 v[180:183], v[64:67], v[100:103], v[180:183]
    ds_read_b64_tr_b16 v[88:89], v13 offset:0
    v_mfma_f32_16x16x32_bf16 v[184:187], v[64:67], v[104:107], v[184:187]
    ds_read_b64_tr_b16 v[90:91], v13 offset:1280
    v_mfma_f32_16x16x32_bf16 v[188:191], v[64:67], v[108:111], v[188:191]
    v_mfma_f32_16x16x32_bf16 v[192:195], v[68:71], v[92:95], v[192:195]
    v_mfma_f32_16x16x32_bf16 v[196:199], v[68:71], v[96:99], v[196:199]
    v_mfma_f32_16x16x32_bf16 v[200:203], v[68:71], v[100:103], v[200:203]
    v_mfma_f32_16x16x32_bf16 v[204:207], v[68:71], v[104:107], v[204:207]
    v_mfma_f32_16x16x32_bf16 v[208:211], v[68:71], v[108:111], v[208:211]
    s_waitcnt lgkmcnt(0)
    v_mfma_f32_16x16x32_bf16 v[212:215], v[112:115], v[40:43], v[212:215]
    ds_read_b128 v[56:59], v8 offset:16384
    v_mfma_f32_16x16x32_bf16 v[232:235], v[112:115], v[44:47], v[232:235]
    ds_read_b128 v[60:63], v8 offset:18432
    v_mfma_f32_16x16x32_bf16 v[216:219], v[116:119], v[40:43], v[216:219]
    ds_read_b128 v[64:67], v23 offset:16384
    v_mfma_f32_16x16x32_bf16 v[236:239], v[116:119], v[44:47], v[236:239]
    ds_read_b128 v[68:71], v23 offset:18432
    v_mfma_f32_16x16x32_bf16 v[220:223], v[120:123], v[40:43], v[220:223]
    ds_read_b64_tr_b16 v[92:93], v9 offset:10240
    v_mfma_f32_16x16x32_bf16 v[240:243], v[120:123], v[44:47], v[240:243]
    ds_read_b64_tr_b16 v[94:95], v9 offset:11520
    v_mfma_f32_16x16x32_bf16 v[224:227], v[124:127], v[40:43], v[224:227]
    ds_read_b64_tr_b16 v[96:97], v10 offset:10240
    v_mfma_f32_16x16x32_bf16 v[244:247], v[124:127], v[44:47], v[244:247]
    ds_read_b64_tr_b16 v[98:99], v10 offset:11520
    v_mfma_f32_16x16x32_bf16 v[228:231], v[128:131], v[40:43], v[228:231]
    ds_read_b64_tr_b16 v[100:101], v11 offset:10240
    v_mfma_f32_16x16x32_bf16 v[248:251], v[128:131], v[44:47], v[248:251]
    ds_read_b64_tr_b16 v[102:103], v11 offset:11520
    v_mfma_f32_16x16x32_bf16 v[132:135], v[40:43], v[72:75], v[132:135]
    ds_read_b64_tr_b16 v[112:113], v20 offset:26880
    v_mfma_f32_16x16x32_bf16 v[136:139], v[40:43], v[76:79], v[136:139]
    ds_read_b64_tr_b16 v[114:115], v20 offset:27520
    v_mfma_f32_16x16x32_bf16 v[140:143], v[40:43], v[80:83], v[140:143]
    ds_read_b64_tr_b16 v[116:117], v20 offset:26920
    v_mfma_f32_16x16x32_bf16 v[144:147], v[40:43], v[84:87], v[144:147]
    ds_read_b64_tr_b16 v[118:119], v20 offset:27560
    v_mfma_f32_16x16x32_bf16 v[148:151], v[40:43], v[88:91], v[148:151]
    ds_read_b64_tr_b16 v[120:121], v20 offset:26960
    v_mfma_f32_16x16x32_bf16 v[152:155], v[44:47], v[72:75], v[152:155]
    ds_read_b64_tr_b16 v[122:123], v20 offset:27600
    v_mfma_f32_16x16x32_bf16 v[156:159], v[44:47], v[76:79], v[156:159]
    ds_read_b64_tr_b16 v[124:125], v20 offset:27000
    v_mfma_f32_16x16x32_bf16 v[160:163], v[44:47], v[80:83], v[160:163]
    ds_read_b64_tr_b16 v[126:127], v20 offset:27640
    v_mfma_f32_16x16x32_bf16 v[164:167], v[44:47], v[84:87], v[164:167]
    ds_read_b64_tr_b16 v[128:129], v21 offset:26880
    v_mfma_f32_16x16x32_bf16 v[168:171], v[44:47], v[88:91], v[168:171]
    ds_read_b64_tr_b16 v[130:131], v21 offset:27520
    v_mfma_f32_16x16x32_bf16 v[172:175], v[48:51], v[72:75], v[172:175]
    ds_read_b64_tr_b16 v[104:105], v12 offset:10240
    v_mfma_f32_16x16x32_bf16 v[176:179], v[48:51], v[76:79], v[176:179]
    ds_read_b64_tr_b16 v[106:107], v12 offset:11520
    v_mfma_f32_16x16x32_bf16 v[180:183], v[48:51], v[80:83], v[180:183]
    ds_read_b64_tr_b16 v[108:109], v13 offset:10240
    v_mfma_f32_16x16x32_bf16 v[184:187], v[48:51], v[84:87], v[184:187]
    ds_read_b64_tr_b16 v[110:111], v13 offset:11520
    v_mfma_f32_16x16x32_bf16 v[188:191], v[48:51], v[88:91], v[188:191]
    v_mfma_f32_16x16x32_bf16 v[192:195], v[52:55], v[72:75], v[192:195]
    v_mfma_f32_16x16x32_bf16 v[196:199], v[52:55], v[76:79], v[196:199]
    v_mfma_f32_16x16x32_bf16 v[200:203], v[52:55], v[80:83], v[200:203]
    v_mfma_f32_16x16x32_bf16 v[204:207], v[52:55], v[84:87], v[204:207]
    v_mfma_f32_16x16x32_bf16 v[208:211], v[52:55], v[88:91], v[208:211]
    s_waitcnt lgkmcnt(0)
    s_barrier
    v_mfma_f32_16x16x32_bf16 v[212:215], v[112:115], v[56:59], v[212:215]
    ds_read_b128 v[40:43], v7 offset:32768
    v_mfma_f32_16x16x32_bf16 v[232:235], v[112:115], v[60:63], v[232:235]
    ds_read_b128 v[44:47], v7 offset:34816
    v_mfma_f32_16x16x32_bf16 v[216:219], v[116:119], v[56:59], v[216:219]
    ds_read_b128 v[48:51], v22 offset:32768
    v_mfma_f32_16x16x32_bf16 v[236:239], v[116:119], v[60:63], v[236:239]
    ds_read_b128 v[52:55], v22 offset:34816
    v_mfma_f32_16x16x32_bf16 v[220:223], v[120:123], v[56:59], v[220:223]
    ds_read_b64_tr_b16 v[72:73], v9 offset:20480
    v_mfma_f32_16x16x32_bf16 v[240:243], v[120:123], v[60:63], v[240:243]
    ds_read_b64_tr_b16 v[74:75], v9 offset:21760
    v_mfma_f32_16x16x32_bf16 v[224:227], v[124:127], v[56:59], v[224:227]
    ds_read_b64_tr_b16 v[76:77], v10 offset:20480
    v_mfma_f32_16x16x32_bf16 v[244:247], v[124:127], v[60:63], v[244:247]
    ds_read_b64_tr_b16 v[78:79], v10 offset:21760
    v_mfma_f32_16x16x32_bf16 v[228:231], v[128:131], v[56:59], v[228:231]
    ds_read_b64_tr_b16 v[80:81], v11 offset:20480
    v_mfma_f32_16x16x32_bf16 v[248:251], v[128:131], v[60:63], v[248:251]
    ds_read_b64_tr_b16 v[82:83], v11 offset:21760
    v_mfma_f32_16x16x32_bf16 v[132:135], v[56:59], v[92:95], v[132:135]
    ds_read_b64_tr_b16 v[112:113], v20 offset:0
    v_mfma_f32_16x16x32_bf16 v[136:139], v[56:59], v[96:99], v[136:139]
    ds_read_b64_tr_b16 v[114:115], v20 offset:640
    v_mfma_f32_16x16x32_bf16 v[140:143], v[56:59], v[100:103], v[140:143]
    ds_read_b64_tr_b16 v[116:117], v20 offset:40
    v_mfma_f32_16x16x32_bf16 v[144:147], v[56:59], v[104:107], v[144:147]
    ds_read_b64_tr_b16 v[118:119], v20 offset:680
    v_mfma_f32_16x16x32_bf16 v[148:151], v[56:59], v[108:111], v[148:151]
    ds_read_b64_tr_b16 v[120:121], v20 offset:80
    v_mfma_f32_16x16x32_bf16 v[152:155], v[60:63], v[92:95], v[152:155]
    ds_read_b64_tr_b16 v[122:123], v20 offset:720
    v_mfma_f32_16x16x32_bf16 v[156:159], v[60:63], v[96:99], v[156:159]
    ds_read_b64_tr_b16 v[124:125], v20 offset:120
    v_mfma_f32_16x16x32_bf16 v[160:163], v[60:63], v[100:103], v[160:163]
    ds_read_b64_tr_b16 v[126:127], v20 offset:760
    v_mfma_f32_16x16x32_bf16 v[164:167], v[60:63], v[104:107], v[164:167]
    ds_read_b64_tr_b16 v[128:129], v21 offset:0
    v_mfma_f32_16x16x32_bf16 v[168:171], v[60:63], v[108:111], v[168:171]
    ds_read_b64_tr_b16 v[130:131], v21 offset:640
    v_mfma_f32_16x16x32_bf16 v[172:175], v[64:67], v[92:95], v[172:175]
    ds_read_b64_tr_b16 v[84:85], v12 offset:20480
    v_mfma_f32_16x16x32_bf16 v[176:179], v[64:67], v[96:99], v[176:179]
    ds_read_b64_tr_b16 v[86:87], v12 offset:21760
    v_mfma_f32_16x16x32_bf16 v[180:183], v[64:67], v[100:103], v[180:183]
    ds_read_b64_tr_b16 v[88:89], v13 offset:20480
    v_mfma_f32_16x16x32_bf16 v[184:187], v[64:67], v[104:107], v[184:187]
    ds_read_b64_tr_b16 v[90:91], v13 offset:21760
    v_mfma_f32_16x16x32_bf16 v[188:191], v[64:67], v[108:111], v[188:191]
    v_mfma_f32_16x16x32_bf16 v[192:195], v[68:71], v[92:95], v[192:195]
    v_mfma_f32_16x16x32_bf16 v[196:199], v[68:71], v[96:99], v[196:199]
    v_mfma_f32_16x16x32_bf16 v[200:203], v[68:71], v[100:103], v[200:203]
    v_mfma_f32_16x16x32_bf16 v[204:207], v[68:71], v[104:107], v[204:207]
    v_mfma_f32_16x16x32_bf16 v[208:211], v[68:71], v[108:111], v[208:211]
    s_waitcnt lgkmcnt(0)
    v_mfma_f32_16x16x32_bf16 v[212:215], v[112:115], v[40:43], v[212:215]
    ds_read_b128 v[56:59], v8 offset:32768
    v_mfma_f32_16x16x32_bf16 v[232:235], v[112:115], v[44:47], v[232:235]
    ds_read_b128 v[60:63], v8 offset:34816
    v_mfma_f32_16x16x32_bf16 v[216:219], v[116:119], v[40:43], v[216:219]
    ds_read_b128 v[64:67], v23 offset:32768
    v_mfma_f32_16x16x32_bf16 v[236:239], v[116:119], v[44:47], v[236:239]
    ds_read_b128 v[68:71], v23 offset:34816
    v_mfma_f32_16x16x32_bf16 v[220:223], v[120:123], v[40:43], v[220:223]
    ds_read_b64_tr_b16 v[92:93], v9 offset:30720
    v_mfma_f32_16x16x32_bf16 v[240:243], v[120:123], v[44:47], v[240:243]
    ds_read_b64_tr_b16 v[94:95], v9 offset:32000
    v_mfma_f32_16x16x32_bf16 v[224:227], v[124:127], v[40:43], v[224:227]
    ds_read_b64_tr_b16 v[96:97], v10 offset:30720
    v_mfma_f32_16x16x32_bf16 v[244:247], v[124:127], v[44:47], v[244:247]
    ds_read_b64_tr_b16 v[98:99], v10 offset:32000
    v_mfma_f32_16x16x32_bf16 v[228:231], v[128:131], v[40:43], v[228:231]
    ds_read_b64_tr_b16 v[100:101], v11 offset:30720
    v_mfma_f32_16x16x32_bf16 v[248:251], v[128:131], v[44:47], v[248:251]
    ds_read_b64_tr_b16 v[102:103], v11 offset:32000
    v_mfma_f32_16x16x32_bf16 v[132:135], v[40:43], v[72:75], v[132:135]
    ds_read_b64_tr_b16 v[112:113], v20 offset:5376
    v_mfma_f32_16x16x32_bf16 v[136:139], v[40:43], v[76:79], v[136:139]
    ds_read_b64_tr_b16 v[114:115], v20 offset:6016
    v_mfma_f32_16x16x32_bf16 v[140:143], v[40:43], v[80:83], v[140:143]
    ds_read_b64_tr_b16 v[116:117], v20 offset:5416
    v_mfma_f32_16x16x32_bf16 v[144:147], v[40:43], v[84:87], v[144:147]
    ds_read_b64_tr_b16 v[118:119], v20 offset:6056
    v_mfma_f32_16x16x32_bf16 v[148:151], v[40:43], v[88:91], v[148:151]
    ds_read_b64_tr_b16 v[120:121], v20 offset:5456
    v_mfma_f32_16x16x32_bf16 v[152:155], v[44:47], v[72:75], v[152:155]
    ds_read_b64_tr_b16 v[122:123], v20 offset:6096
    v_mfma_f32_16x16x32_bf16 v[156:159], v[44:47], v[76:79], v[156:159]
    ds_read_b64_tr_b16 v[124:125], v20 offset:5496
    v_mfma_f32_16x16x32_bf16 v[160:163], v[44:47], v[80:83], v[160:163]
    ds_read_b64_tr_b16 v[126:127], v20 offset:6136
    v_mfma_f32_16x16x32_bf16 v[164:167], v[44:47], v[84:87], v[164:167]
    ds_read_b64_tr_b16 v[128:129], v21 offset:5376
    v_mfma_f32_16x16x32_bf16 v[168:171], v[44:47], v[88:91], v[168:171]
    ds_read_b64_tr_b16 v[130:131], v21 offset:6016
    v_mfma_f32_16x16x32_bf16 v[172:175], v[48:51], v[72:75], v[172:175]
    ds_read_b64_tr_b16 v[104:105], v12 offset:30720
    v_mfma_f32_16x16x32_bf16 v[176:179], v[48:51], v[76:79], v[176:179]
    ds_read_b64_tr_b16 v[106:107], v12 offset:32000
    v_mfma_f32_16x16x32_bf16 v[180:183], v[48:51], v[80:83], v[180:183]
    ds_read_b64_tr_b16 v[108:109], v13 offset:30720
    v_mfma_f32_16x16x32_bf16 v[184:187], v[48:51], v[84:87], v[184:187]
    ds_read_b64_tr_b16 v[110:111], v13 offset:32000
    v_mfma_f32_16x16x32_bf16 v[188:191], v[48:51], v[88:91], v[188:191]
    v_mfma_f32_16x16x32_bf16 v[192:195], v[52:55], v[72:75], v[192:195]
    v_mfma_f32_16x16x32_bf16 v[196:199], v[52:55], v[76:79], v[196:199]
    v_mfma_f32_16x16x32_bf16 v[200:203], v[52:55], v[80:83], v[200:203]
    v_mfma_f32_16x16x32_bf16 v[204:207], v[52:55], v[84:87], v[204:207]
    v_mfma_f32_16x16x32_bf16 v[208:211], v[52:55], v[88:91], v[208:211]
    s_waitcnt lgkmcnt(0)
    s_barrier
    v_mfma_f32_16x16x32_bf16 v[212:215], v[112:115], v[56:59], v[212:215]
    ds_read_b128 v[40:43], v7 offset:0
    v_mfma_f32_16x16x32_bf16 v[232:235], v[112:115], v[60:63], v[232:235]
    ds_read_b128 v[44:47], v7 offset:2048
    v_mfma_f32_16x16x32_bf16 v[216:219], v[116:119], v[56:59], v[216:219]
    ds_read_b128 v[48:51], v22 offset:0
    v_mfma_f32_16x16x32_bf16 v[236:239], v[116:119], v[60:63], v[236:239]
    ds_read_b128 v[52:55], v22 offset:2048
    v_mfma_f32_16x16x32_bf16 v[220:223], v[120:123], v[56:59], v[220:223]
    ds_read_b64_tr_b16 v[72:73], v9 offset:40960
    v_mfma_f32_16x16x32_bf16 v[240:243], v[120:123], v[60:63], v[240:243]
    ds_read_b64_tr_b16 v[74:75], v9 offset:42240
    v_mfma_f32_16x16x32_bf16 v[224:227], v[124:127], v[56:59], v[224:227]
    ds_read_b64_tr_b16 v[76:77], v10 offset:40960
    v_mfma_f32_16x16x32_bf16 v[244:247], v[124:127], v[60:63], v[244:247]
    ds_read_b64_tr_b16 v[78:79], v10 offset:42240
    v_mfma_f32_16x16x32_bf16 v[228:231], v[128:131], v[56:59], v[228:231]
    ds_read_b64_tr_b16 v[80:81], v11 offset:40960
    v_mfma_f32_16x16x32_bf16 v[248:251], v[128:131], v[60:63], v[248:251]
    ds_read_b64_tr_b16 v[82:83], v11 offset:42240
    v_mfma_f32_16x16x32_bf16 v[132:135], v[56:59], v[92:95], v[132:135]
    ds_read_b64_tr_b16 v[84:85], v12 offset:40960
    v_mfma_f32_16x16x32_bf16 v[136:139], v[56:59], v[96:99], v[136:139]
    ds_read_b64_tr_b16 v[86:87], v12 offset:42240
    v_mfma_f32_16x16x32_bf16 v[140:143], v[56:59], v[100:103], v[140:143]
    ds_read_b64_tr_b16 v[88:89], v13 offset:40960
    v_mfma_f32_16x16x32_bf16 v[144:147], v[56:59], v[104:107], v[144:147]
    ds_read_b64_tr_b16 v[90:91], v13 offset:42240
    v_mfma_f32_16x16x32_bf16 v[148:151], v[56:59], v[108:111], v[148:151]
    v_mfma_f32_16x16x32_bf16 v[152:155], v[60:63], v[92:95], v[152:155]
    v_mfma_f32_16x16x32_bf16 v[156:159], v[60:63], v[96:99], v[156:159]
    v_mfma_f32_16x16x32_bf16 v[160:163], v[60:63], v[100:103], v[160:163]
    v_mfma_f32_16x16x32_bf16 v[164:167], v[60:63], v[104:107], v[164:167]
    v_mfma_f32_16x16x32_bf16 v[168:171], v[60:63], v[108:111], v[168:171]
    v_mfma_f32_16x16x32_bf16 v[172:175], v[64:67], v[92:95], v[172:175]
    v_mfma_f32_16x16x32_bf16 v[176:179], v[64:67], v[96:99], v[176:179]
    v_mfma_f32_16x16x32_bf16 v[180:183], v[64:67], v[100:103], v[180:183]
    v_mfma_f32_16x16x32_bf16 v[184:187], v[64:67], v[104:107], v[184:187]
    v_mfma_f32_16x16x32_bf16 v[188:191], v[64:67], v[108:111], v[188:191]
    v_mfma_f32_16x16x32_bf16 v[192:195], v[68:71], v[92:95], v[192:195]
    v_mfma_f32_16x16x32_bf16 v[196:199], v[68:71], v[96:99], v[196:199]
    v_mfma_f32_16x16x32_bf16 v[200:203], v[68:71], v[100:103], v[200:203]
    v_mfma_f32_16x16x32_bf16 v[204:207], v[68:71], v[104:107], v[204:207]
    v_mfma_f32_16x16x32_bf16 v[208:211], v[68:71], v[108:111], v[208:211]
    s_waitcnt lgkmcnt(0)
    v_mfma_f32_16x16x32_bf16 v[132:135], v[40:43], v[72:75], v[132:135]
    ds_read_b128 v[56:59], v8 offset:0
    v_mfma_f32_16x16x32_bf16 v[136:139], v[40:43], v[76:79], v[136:139]
    ds_read_b128 v[60:63], v8 offset:2048
    v_mfma_f32_16x16x32_bf16 v[140:143], v[40:43], v[80:83], v[140:143]
    ds_read_b128 v[64:67], v23 offset:0
    v_mfma_f32_16x16x32_bf16 v[144:147], v[40:43], v[84:87], v[144:147]
    ds_read_b128 v[68:71], v23 offset:2048
    v_mfma_f32_16x16x32_bf16 v[148:151], v[40:43], v[88:91], v[148:151]
    ds_read_b64_tr_b16 v[92:93], v9 offset:51200
    v_mfma_f32_16x16x32_bf16 v[152:155], v[44:47], v[72:75], v[152:155]
    ds_read_b64_tr_b16 v[94:95], v9 offset:52480
    v_mfma_f32_16x16x32_bf16 v[156:159], v[44:47], v[76:79], v[156:159]
    ds_read_b64_tr_b16 v[96:97], v10 offset:51200
    v_mfma_f32_16x16x32_bf16 v[160:163], v[44:47], v[80:83], v[160:163]
    ds_read_b64_tr_b16 v[98:99], v10 offset:52480
    v_mfma_f32_16x16x32_bf16 v[164:167], v[44:47], v[84:87], v[164:167]
    ds_read_b64_tr_b16 v[100:101], v11 offset:51200
    v_mfma_f32_16x16x32_bf16 v[168:171], v[44:47], v[88:91], v[168:171]
    ds_read_b64_tr_b16 v[102:103], v11 offset:52480
    v_mfma_f32_16x16x32_bf16 v[172:175], v[48:51], v[72:75], v[172:175]
    ds_read_b64_tr_b16 v[104:105], v12 offset:51200
    v_mfma_f32_16x16x32_bf16 v[176:179], v[48:51], v[76:79], v[176:179]
    ds_read_b64_tr_b16 v[106:107], v12 offset:52480
    v_mfma_f32_16x16x32_bf16 v[180:183], v[48:51], v[80:83], v[180:183]
    ds_read_b64_tr_b16 v[108:109], v13 offset:51200
    v_mfma_f32_16x16x32_bf16 v[184:187], v[48:51], v[84:87], v[184:187]
    ds_read_b64_tr_b16 v[110:111], v13 offset:52480
    v_mfma_f32_16x16x32_bf16 v[188:191], v[48:51], v[88:91], v[188:191]
    v_mfma_f32_16x16x32_bf16 v[192:195], v[52:55], v[72:75], v[192:195]
    v_mfma_f32_16x16x32_bf16 v[196:199], v[52:55], v[76:79], v[196:199]
    v_mfma_f32_16x16x32_bf16 v[200:203], v[52:55], v[80:83], v[200:203]
    v_mfma_f32_16x16x32_bf16 v[204:207], v[52:55], v[84:87], v[204:207]
    v_mfma_f32_16x16x32_bf16 v[208:211], v[52:55], v[88:91], v[208:211]
    s_waitcnt lgkmcnt(0)
    s_barrier
    v_mfma_f32_16x16x32_bf16 v[132:135], v[56:59], v[92:95], v[132:135]
    ds_read_b128 v[40:43], v7 offset:16384
    v_mfma_f32_16x16x32_bf16 v[136:139], v[56:59], v[96:99], v[136:139]
    ds_read_b128 v[44:47], v7 offset:18432
    v_mfma_f32_16x16x32_bf16 v[140:143], v[56:59], v[100:103], v[140:143]
    ds_read_b128 v[48:51], v22 offset:16384
    v_mfma_f32_16x16x32_bf16 v[144:147], v[56:59], v[104:107], v[144:147]
    ds_read_b128 v[52:55], v22 offset:18432
    v_mfma_f32_16x16x32_bf16 v[148:151], v[56:59], v[108:111], v[148:151]
    ds_read_b64_tr_b16 v[72:73], v9 offset:0
    v_mfma_f32_16x16x32_bf16 v[152:155], v[60:63], v[92:95], v[152:155]
    ds_read_b64_tr_b16 v[74:75], v9 offset:1280
    v_mfma_f32_16x16x32_bf16 v[156:159], v[60:63], v[96:99], v[156:159]
    ds_read_b64_tr_b16 v[76:77], v10 offset:0
    v_mfma_f32_16x16x32_bf16 v[160:163], v[60:63], v[100:103], v[160:163]
    ds_read_b64_tr_b16 v[78:79], v10 offset:1280
    v_mfma_f32_16x16x32_bf16 v[164:167], v[60:63], v[104:107], v[164:167]
    ds_read_b64_tr_b16 v[80:81], v11 offset:0
    v_mfma_f32_16x16x32_bf16 v[168:171], v[60:63], v[108:111], v[168:171]
    ds_read_b64_tr_b16 v[82:83], v11 offset:1280
    v_mfma_f32_16x16x32_bf16 v[172:175], v[64:67], v[92:95], v[172:175]
    ds_read_b64_tr_b16 v[84:85], v12 offset:0
    v_mfma_f32_16x16x32_bf16 v[176:179], v[64:67], v[96:99], v[176:179]
    ds_read_b64_tr_b16 v[86:87], v12 offset:1280
    v_mfma_f32_16x16x32_bf16 v[180:183], v[64:67], v[100:103], v[180:183]
    ds_read_b64_tr_b16 v[88:89], v13 offset:0
    v_mfma_f32_16x16x32_bf16 v[184:187], v[64:67], v[104:107], v[184:187]
    ds_read_b64_tr_b16 v[90:91], v13 offset:1280
    v_mfma_f32_16x16x32_bf16 v[188:191], v[64:67], v[108:111], v[188:191]
    v_mfma_f32_16x16x32_bf16 v[192:195], v[68:71], v[92:95], v[192:195]
    v_mfma_f32_16x16x32_bf16 v[196:199], v[68:71], v[96:99], v[196:199]
    v_mfma_f32_16x16x32_bf16 v[200:203], v[68:71], v[100:103], v[200:203]
    v_mfma_f32_16x16x32_bf16 v[204:207], v[68:71], v[104:107], v[204:207]
    v_mfma_f32_16x16x32_bf16 v[208:211], v[68:71], v[108:111], v[208:211]
    s_waitcnt lgkmcnt(0)
    v_mfma_f32_16x16x32_bf16 v[132:135], v[40:43], v[72:75], v[132:135]
    ds_read_b128 v[56:59], v8 offset:16384
    v_mfma_f32_16x16x32_bf16 v[136:139], v[40:43], v[76:79], v[136:139]
    ds_read_b128 v[60:63], v8 offset:18432
    v_mfma_f32_16x16x32_bf16 v[140:143], v[40:43], v[80:83], v[140:143]
    ds_read_b128 v[64:67], v23 offset:16384
    v_mfma_f32_16x16x32_bf16 v[144:147], v[40:43], v[84:87], v[144:147]
    ds_read_b128 v[68:71], v23 offset:18432
    v_mfma_f32_16x16x32_bf16 v[148:151], v[40:43], v[88:91], v[148:151]
    ds_read_b64_tr_b16 v[92:93], v9 offset:10240
    v_mfma_f32_16x16x32_bf16 v[152:155], v[44:47], v[72:75], v[152:155]
    ds_read_b64_tr_b16 v[94:95], v9 offset:11520
    v_mfma_f32_16x16x32_bf16 v[156:159], v[44:47], v[76:79], v[156:159]
    ds_read_b64_tr_b16 v[96:97], v10 offset:10240
    v_mfma_f32_16x16x32_bf16 v[160:163], v[44:47], v[80:83], v[160:163]
    ds_read_b64_tr_b16 v[98:99], v10 offset:11520
    v_mfma_f32_16x16x32_bf16 v[164:167], v[44:47], v[84:87], v[164:167]
    ds_read_b64_tr_b16 v[100:101], v11 offset:10240
    v_mfma_f32_16x16x32_bf16 v[168:171], v[44:47], v[88:91], v[168:171]
    ds_read_b64_tr_b16 v[102:103], v11 offset:11520
    v_mfma_f32_16x16x32_bf16 v[172:175], v[48:51], v[72:75], v[172:175]
    ds_read_b64_tr_b16 v[104:105], v12 offset:10240
    v_mfma_f32_16x16x32_bf16 v[176:179], v[48:51], v[76:79], v[176:179]
    ds_read_b64_tr_b16 v[106:107], v12 offset:11520
    v_mfma_f32_16x16x32_bf16 v[180:183], v[48:51], v[80:83], v[180:183]
    ds_read_b64_tr_b16 v[108:109], v13 offset:10240
    v_mfma_f32_16x16x32_bf16 v[184:187], v[48:51], v[84:87], v[184:187]
    ds_read_b64_tr_b16 v[110:111], v13 offset:11520
    v_mfma_f32_16x16x32_bf16 v[188:191], v[48:51], v[88:91], v[188:191]
    v_mfma_f32_16x16x32_bf16 v[192:195], v[52:55], v[72:75], v[192:195]
    v_mfma_f32_16x16x32_bf16 v[196:199], v[52:55], v[76:79], v[196:199]
    v_mfma_f32_16x16x32_bf16 v[200:203], v[52:55], v[80:83], v[200:203]
    v_mfma_f32_16x16x32_bf16 v[204:207], v[52:55], v[84:87], v[204:207]
    v_mfma_f32_16x16x32_bf16 v[208:211], v[52:55], v[88:91], v[208:211]
    s_waitcnt lgkmcnt(0)
    s_barrier
    v_mfma_f32_16x16x32_bf16 v[132:135], v[56:59], v[92:95], v[132:135]
    v_mfma_f32_16x16x32_bf16 v[136:139], v[56:59], v[96:99], v[136:139]
    v_mfma_f32_16x16x32_bf16 v[140:143], v[56:59], v[100:103], v[140:143]
    v_mfma_f32_16x16x32_bf16 v[144:147], v[56:59], v[104:107], v[144:147]
    v_mfma_f32_16x16x32_bf16 v[148:151], v[56:59], v[108:111], v[148:151]
    v_mfma_f32_16x16x32_bf16 v[152:155], v[60:63], v[92:95], v[152:155]
    v_mfma_f32_16x16x32_bf16 v[156:159], v[60:63], v[96:99], v[156:159]
    v_mfma_f32_16x16x32_bf16 v[160:163], v[60:63], v[100:103], v[160:163]
    v_mfma_f32_16x16x32_bf16 v[164:167], v[60:63], v[104:107], v[164:167]
    v_mfma_f32_16x16x32_bf16 v[168:171], v[60:63], v[108:111], v[168:171]
    v_mfma_f32_16x16x32_bf16 v[172:175], v[64:67], v[92:95], v[172:175]
    v_cmp_gt_u32 vcc, 8, v2
    v_mov_b32 v4, 0x3f803f80
    v_mfma_f32_16x16x32_bf16 v[176:179], v[64:67], v[96:99], v[176:179]
    v_cvt_pk_bf16_f32 v48, v140, v141
    v_cvt_pk_bf16_f32 v49, v142, v143
    v_mfma_f32_16x16x32_bf16 v[180:183], v[64:67], v[100:103], v[180:183]
    v_cvt_pk_bf16_f32 v52, v144, v145
    v_cvt_pk_bf16_f32 v53, v146, v147
    v_mfma_f32_16x16x32_bf16 v[184:187], v[64:67], v[104:107], v[184:187]
    v_cvt_pk_bf16_f32 v76, v148, v149
    v_cvt_pk_bf16_f32 v77, v150, v151
    v_mfma_f32_16x16x32_bf16 v[188:191], v[64:67], v[108:111], v[188:191]
    v_cndmask_b32 v76, v76, v4, vcc
    v_cndmask_b32 v77, v77, v4, vcc
    v_mfma_f32_16x16x32_bf16 v[192:195], v[68:71], v[92:95], v[192:195]
    v_pk_mul_f32 v[36:37], v[132:133], s[66:67]
    v_pk_mul_f32 v[38:39], v[134:135], s[66:67]
    v_mfma_f32_16x16x32_bf16 v[196:199], v[68:71], v[96:99], v[196:199]
    v_exp_f32_e64 v36, v36 clamp
    v_exp_f32_e64 v37, v37 clamp
    v_mfma_f32_16x16x32_bf16 v[200:203], v[68:71], v[100:103], v[200:203]
    v_exp_f32_e64 v38, v38 clamp
    v_exp_f32_e64 v39, v39 clamp
    v_mfma_f32_16x16x32_bf16 v[204:207], v[68:71], v[104:107], v[204:207]
    v_max_f32 v132, s64, v132
    v_max_f32 v133, s64, v133
    v_mfma_f32_16x16x32_bf16 v[208:211], v[68:71], v[108:111], v[208:211]
    v_max_f32 v134, s64, v134
    v_max_f32 v135, s64, v135
    v_pk_add_f32 v[132:133], v[132:133], v[36:37]
    v_pk_add_f32 v[134:135], v[134:135], v[38:39]
    v_cvt_pk_bf16_f32 v40, v132, v133
    v_cvt_pk_bf16_f32 v41, v134, v135
    v_pk_mul_f32 v[36:37], v[136:137], s[66:67]
    v_pk_mul_f32 v[38:39], v[138:139], s[66:67]
    v_exp_f32_e64 v36, v36 clamp
    v_exp_f32_e64 v37, v37 clamp
    v_exp_f32_e64 v38, v38 clamp
    v_exp_f32_e64 v39, v39 clamp
    v_max_f32 v136, s64, v136
    v_max_f32 v137, s64, v137
    v_max_f32 v138, s64, v138
    v_max_f32 v139, s64, v139
    v_pk_add_f32 v[136:137], v[136:137], v[36:37]
    v_pk_add_f32 v[138:139], v[138:139], v[38:39]
    v_cvt_pk_bf16_f32 v44, v136, v137
    v_cvt_pk_bf16_f32 v45, v138, v139
    v_pk_mul_f32 v[36:37], v[148:149], s[66:67]
    v_pk_mul_f32 v[38:39], v[150:151], s[66:67]
    v_exp_f32_e64 v36, v36 clamp
    v_exp_f32_e64 v37, v37 clamp
    v_exp_f32_e64 v38, v38 clamp
    v_exp_f32_e64 v39, v39 clamp
    v_max_f32 v148, s64, v148
    v_max_f32 v149, s64, v149
    v_max_f32 v150, s64, v150
    v_max_f32 v151, s64, v151
    v_pk_add_f32 v[148:149], v[148:149], v[36:37]
    v_pk_add_f32 v[150:151], v[150:151], v[38:39]
    v_cvt_pk_bf16_f32 v72, v148, v149
    v_cvt_pk_bf16_f32 v73, v150, v151
    v_cvt_pk_bf16_f32 v50, v160, v161
    v_cvt_pk_bf16_f32 v51, v162, v163
    v_cvt_pk_bf16_f32 v54, v164, v165
    v_cvt_pk_bf16_f32 v55, v166, v167
    v_cvt_pk_bf16_f32 v78, v168, v169
    v_cvt_pk_bf16_f32 v79, v170, v171
    v_cndmask_b32 v78, v78, v4, vcc
    v_cndmask_b32 v79, v79, v4, vcc
    v_pk_mul_f32 v[36:37], v[152:153], s[66:67]
    v_pk_mul_f32 v[38:39], v[154:155], s[66:67]
    v_exp_f32_e64 v36, v36 clamp
    v_exp_f32_e64 v37, v37 clamp
    v_exp_f32_e64 v38, v38 clamp
    v_exp_f32_e64 v39, v39 clamp
    v_max_f32 v152, s64, v152
    v_max_f32 v153, s64, v153
    v_max_f32 v154, s64, v154
    v_max_f32 v155, s64, v155
    v_pk_add_f32 v[152:153], v[152:153], v[36:37]
    v_pk_add_f32 v[154:155], v[154:155], v[38:39]
    v_cvt_pk_bf16_f32 v42, v152, v153
    v_cvt_pk_bf16_f32 v43, v154, v155
    v_pk_mul_f32 v[36:37], v[156:157], s[66:67]
    v_pk_mul_f32 v[38:39], v[158:159], s[66:67]
    v_exp_f32_e64 v36, v36 clamp
    v_exp_f32_e64 v37, v37 clamp
    v_exp_f32_e64 v38, v38 clamp
    v_exp_f32_e64 v39, v39 clamp
    v_max_f32 v156, s64, v156
    v_max_f32 v157, s64, v157
    v_max_f32 v158, s64, v158
    v_max_f32 v159, s64, v159
    v_pk_add_f32 v[156:157], v[156:157], v[36:37]
    v_pk_add_f32 v[158:159], v[158:159], v[38:39]
    v_cvt_pk_bf16_f32 v46, v156, v157
    v_cvt_pk_bf16_f32 v47, v158, v159
    v_pk_mul_f32 v[36:37], v[168:169], s[66:67]
    v_pk_mul_f32 v[38:39], v[170:171], s[66:67]
    v_exp_f32_e64 v36, v36 clamp
    v_exp_f32_e64 v37, v37 clamp
    v_exp_f32_e64 v38, v38 clamp
    v_exp_f32_e64 v39, v39 clamp
    v_max_f32 v168, s64, v168
    v_max_f32 v169, s64, v169
    v_max_f32 v170, s64, v170
    v_max_f32 v171, s64, v171
    v_pk_add_f32 v[168:169], v[168:169], v[36:37]
    v_pk_add_f32 v[170:171], v[170:171], v[38:39]
    v_cvt_pk_bf16_f32 v74, v168, v169
    v_cvt_pk_bf16_f32 v75, v170, v171
    v_cvt_pk_bf16_f32 v88, v180, v181
    v_cvt_pk_bf16_f32 v89, v182, v183
    v_cvt_pk_bf16_f32 v56, v184, v185
    v_cvt_pk_bf16_f32 v57, v186, v187
    v_mfma_f32_16x16x32_bf16 v[132:135], v[40:43], v[48:51], 0
    v_cvt_pk_bf16_f32 v64, v188, v189
    v_cvt_pk_bf16_f32 v65, v190, v191
    v_cndmask_b32 v64, v64, v4, vcc
    v_cndmask_b32 v65, v65, v4, vcc
    v_pk_mul_f32 v[36:37], v[172:173], s[66:67]
    v_pk_mul_f32 v[38:39], v[174:175], s[66:67]
    v_exp_f32_e64 v36, v36 clamp
    v_exp_f32_e64 v37, v37 clamp
    v_mfma_f32_16x16x32_bf16 v[136:139], v[40:43], v[76:79], 0
    v_exp_f32_e64 v38, v38 clamp
    v_exp_f32_e64 v39, v39 clamp
    v_max_f32 v172, s64, v172
    v_max_f32 v173, s64, v173
    v_max_f32 v174, s64, v174
    v_max_f32 v175, s64, v175
    v_pk_add_f32 v[172:173], v[172:173], v[36:37]
    v_pk_add_f32 v[174:175], v[174:175], v[38:39]
    v_mfma_f32_16x16x32_bf16 v[140:143], v[72:75], v[48:51], 0
    v_cvt_pk_bf16_f32 v80, v172, v173
    v_cvt_pk_bf16_f32 v81, v174, v175
    v_pk_mul_f32 v[36:37], v[176:177], s[66:67]
    v_pk_mul_f32 v[38:39], v[178:179], s[66:67]
    v_exp_f32_e64 v36, v36 clamp
    v_exp_f32_e64 v37, v37 clamp
    v_exp_f32_e64 v38, v38 clamp
    v_exp_f32_e64 v39, v39 clamp
    v_mfma_f32_16x16x32_bf16 v[144:147], v[44:47], v[52:55], 0
    v_max_f32 v176, s64, v176
    v_max_f32 v177, s64, v177
    v_max_f32 v178, s64, v178
    v_max_f32 v179, s64, v179
    v_pk_add_f32 v[176:177], v[176:177], v[36:37]
    v_pk_add_f32 v[178:179], v[178:179], v[38:39]
    v_cvt_pk_bf16_f32 v84, v176, v177
    v_cvt_pk_bf16_f32 v85, v178, v179
    v_mfma_f32_16x16x32_bf16 v[148:151], v[44:47], v[76:79], 0
    v_pk_mul_f32 v[36:37], v[188:189], s[66:67]
    v_pk_mul_f32 v[38:39], v[190:191], s[66:67]
    v_exp_f32_e64 v36, v36 clamp
    v_exp_f32_e64 v37, v37 clamp
    v_exp_f32_e64 v38, v38 clamp
    v_exp_f32_e64 v39, v39 clamp
    v_max_f32 v188, s64, v188
    v_max_f32 v189, s64, v189
    v_mfma_f32_16x16x32_bf16 v[152:155], v[72:75], v[52:55], 0
    v_max_f32 v190, s64, v190
    v_max_f32 v191, s64, v191
    v_pk_add_f32 v[188:189], v[188:189], v[36:37]
    v_pk_add_f32 v[190:191], v[190:191], v[38:39]
    v_cvt_pk_bf16_f32 v60, v188, v189
    v_cvt_pk_bf16_f32 v61, v190, v191
    v_cvt_pk_bf16_f32 v90, v200, v201
    v_cvt_pk_bf16_f32 v91, v202, v203
    v_mfma_f32_16x16x32_bf16 v[156:159], v[72:75], v[76:79], 0
    v_cvt_pk_bf16_f32 v58, v204, v205
    v_cvt_pk_bf16_f32 v59, v206, v207
    v_cvt_pk_bf16_f32 v66, v208, v209
    v_cvt_pk_bf16_f32 v67, v210, v211
    v_cndmask_b32 v66, v66, v4, vcc
    v_cndmask_b32 v67, v67, v4, vcc
    v_pk_mul_f32 v[36:37], v[192:193], s[66:67]
    v_pk_mul_f32 v[38:39], v[194:195], s[66:67]
    v_exp_f32_e64 v36, v36 clamp
    v_exp_f32_e64 v37, v37 clamp
    v_exp_f32_e64 v38, v38 clamp
    v_exp_f32_e64 v39, v39 clamp
    v_max_f32 v192, s64, v192
    v_max_f32 v193, s64, v193
    v_max_f32 v194, s64, v194
    v_max_f32 v195, s64, v195
    v_pk_add_f32 v[192:193], v[192:193], v[36:37]
    v_pk_add_f32 v[194:195], v[194:195], v[38:39]
    v_cvt_pk_bf16_f32 v82, v192, v193
    v_cvt_pk_bf16_f32 v83, v194, v195
    v_pk_mul_f32 v[36:37], v[196:197], s[66:67]
    v_pk_mul_f32 v[38:39], v[198:199], s[66:67]
    v_exp_f32_e64 v36, v36 clamp
    v_exp_f32_e64 v37, v37 clamp
    v_exp_f32_e64 v38, v38 clamp
    v_exp_f32_e64 v39, v39 clamp
    v_max_f32 v196, s64, v196
    v_max_f32 v197, s64, v197
    v_max_f32 v198, s64, v198
    v_max_f32 v199, s64, v199
    v_pk_add_f32 v[196:197], v[196:197], v[36:37]
    v_pk_add_f32 v[198:199], v[198:199], v[38:39]
    v_cvt_pk_bf16_f32 v86, v196, v197
    v_cvt_pk_bf16_f32 v87, v198, v199
    v_pk_mul_f32 v[36:37], v[208:209], s[66:67]
    v_pk_mul_f32 v[38:39], v[210:211], s[66:67]
    v_exp_f32_e64 v36, v36 clamp
    v_exp_f32_e64 v37, v37 clamp
    v_exp_f32_e64 v38, v38 clamp
    v_exp_f32_e64 v39, v39 clamp
    v_max_f32 v208, s64, v208
    v_max_f32 v209, s64, v209
    v_max_f32 v210, s64, v210
    v_max_f32 v211, s64, v211
    v_pk_add_f32 v[208:209], v[208:209], v[36:37]
    v_pk_add_f32 v[210:211], v[210:211], v[38:39]
    v_cvt_pk_bf16_f32 v62, v208, v209
    v_cvt_pk_bf16_f32 v63, v210, v211
    s_nop 1
    v_mfma_f32_16x16x32_bf16 v[132:135], v[80:83], v[88:91], v[132:135]
    v_mfma_f32_16x16x32_bf16 v[136:139], v[80:83], v[64:67], v[136:139]
    v_mfma_f32_16x16x32_bf16 v[140:143], v[60:63], v[88:91], v[140:143]
    v_mfma_f32_16x16x32_bf16 v[144:147], v[84:87], v[56:59], v[144:147]
    v_mfma_f32_16x16x32_bf16 v[148:151], v[84:87], v[64:67], v[148:151]
    v_mfma_f32_16x16x32_bf16 v[152:155], v[60:63], v[56:59], v[152:155]
    v_mfma_f32_16x16x32_bf16 v[156:159], v[60:63], v[64:67], v[156:159]
    s_nop 3
    ds_write_b128 v14, v[132:135]
    ds_write_b128 v14, v[144:147] offset:2240
    s_mov_b32 exec_lo, 0xf010f01
    s_mov_b32 exec_hi, 0xf010f01
    ds_write_b128 v16, v[136:139] offset:0
    s_mov_b32 exec_lo, 0xf001f001
    s_mov_b32 exec_hi, 0xf001f001
    ds_write_b128 v18, v[148:151] offset:2240
    s_mov_b32 exec_lo, 0xffff
    s_mov_b32 exec_hi, 0x0
    ds_write_b128 v15, v[140:143] offset:0
    s_mov_b32 exec_lo, 0xffff0000
    s_mov_b32 exec_hi, 0x0
    ds_write_b128 v15, v[152:155] offset:2240
    s_mov_b32 exec_lo, 0xf01
    s_mov_b32 exec_hi, 0x0
    ds_write_b128 v17, v[156:159] offset:0
    s_mov_b32 exec_lo, 0xf0010000
    s_mov_b32 exec_hi, 0x0
    ds_write_b128 v19, v[156:159] offset:2240
    s_mov_b64 exec, -1
    s_waitcnt lgkmcnt(0)
    s_barrier
    ds_read2st64_b32 v[132:133], v30 offset0:0 offset1:36
    ds_read2st64_b32 v[134:135], v30 offset0:4 offset1:40
    ds_read2st64_b32 v[136:137], v30 offset0:8 offset1:44
    ds_read2st64_b32 v[138:139], v30 offset0:12 offset1:48
    ds_read2st64_b32 v[140:141], v30 offset0:16 offset1:52
    ds_read2st64_b32 v[142:143], v30 offset0:20 offset1:56
    ds_read2st64_b32 v[144:145], v30 offset0:24 offset1:60
    ds_read2st64_b32 v[146:147], v30 offset0:28 offset1:64
    ds_read2st64_b32 v[148:149], v30 offset0:32 offset1:68
    s_waitcnt lgkmcnt(0)
    v_add_f32 v132, v132, v133
    ds_read_b128 v[40:43], v7 offset:0
    ds_read_b128 v[44:47], v7 offset:2048
    buffer_atomic_add_f32 v132, v27, s[40:43], 0 offen offset:0
    ds_read_b64_tr_b16 v[72:73], v20 offset:10752
    v_add_f32 v134, v134, v135
    ds_read_b64_tr_b16 v[74:75], v20 offset:11392
    buffer_atomic_add_f32 v134, v27, s[40:43], 0 offen offset:1024
    ds_read_b64_tr_b16 v[76:77], v20 offset:10792
    ds_read_b64_tr_b16 v[78:79], v20 offset:11432
    v_add_f32 v136, v136, v137
    ds_read_b64_tr_b16 v[80:81], v20 offset:10832
    buffer_atomic_add_f32 v136, v27, s[40:43], 0 offen offset:2048
    ds_read_b64_tr_b16 v[82:83], v20 offset:11472
    v_add_f32 v138, v138, v139
    ds_read_b64_tr_b16 v[84:85], v20 offset:10872
    ds_read_b64_tr_b16 v[86:87], v20 offset:11512
    buffer_atomic_add_f32 v138, v27, s[40:43], 0 offen offset:3072
    ds_read_b64_tr_b16 v[88:89], v21 offset:10752
    v_add_f32 v140, v140, v141
    ds_read_b64_tr_b16 v[90:91], v21 offset:11392
    buffer_atomic_add_f32 v140, v28, s[40:43], 0 offen offset:0
    ds_read_b128 v[56:59], v8 offset:0
    ds_read_b128 v[60:63], v8 offset:2048
    v_add_f32 v142, v142, v143
    ds_read_b64_tr_b16 v[92:93], v20 offset:16128
    buffer_atomic_add_f32 v142, v28, s[40:43], 0 offen offset:1024
    ds_read_b64_tr_b16 v[94:95], v20 offset:16768
    v_add_f32 v144, v144, v145
    ds_read_b64_tr_b16 v[96:97], v20 offset:16168
    ds_read_b64_tr_b16 v[98:99], v20 offset:16808
    buffer_atomic_add_f32 v144, v28, s[40:43], 0 offen offset:2048
    ds_read_b64_tr_b16 v[100:101], v20 offset:16208
    v_add_f32 v146, v146, v147
    ds_read_b64_tr_b16 v[102:103], v20 offset:16848
    buffer_atomic_add_f32 v146, v28, s[40:43], 0 offen offset:3072
    ds_read_b64_tr_b16 v[104:105], v20 offset:16248
    ds_read_b64_tr_b16 v[106:107], v20 offset:16888
    v_add_f32 v148, v148, v149
    ds_read_b64_tr_b16 v[108:109], v21 offset:16128
    buffer_atomic_add_f32 v148, v29, s[40:43], 0 offen offset:0
    ds_read_b64_tr_b16 v[110:111], v21 offset:16768
    s_waitcnt lgkmcnt(0)
    v_mfma_f32_16x16x32_bf16 v[212:215], v[72:75], v[40:43], v[212:215]
    ds_read_b128 v[48:51], v7 offset:16384
    ds_read_b128 v[52:55], v7 offset:18432
    v_mfma_f32_16x16x32_bf16 v[232:235], v[72:75], v[44:47], v[232:235]
    ds_read_b64_tr_b16 v[112:113], v20 offset:21504
    ds_read_b64_tr_b16 v[114:115], v20 offset:22144
    v_mfma_f32_16x16x32_bf16 v[216:219], v[76:79], v[40:43], v[216:219]
    ds_read_b64_tr_b16 v[116:117], v20 offset:21544
    ds_read_b64_tr_b16 v[118:119], v20 offset:22184
    v_mfma_f32_16x16x32_bf16 v[236:239], v[76:79], v[44:47], v[236:239]
    ds_read_b64_tr_b16 v[120:121], v20 offset:21584
    v_mfma_f32_16x16x32_bf16 v[220:223], v[80:83], v[40:43], v[220:223]
    ds_read_b64_tr_b16 v[122:123], v20 offset:22224
    ds_read_b64_tr_b16 v[124:125], v20 offset:21624
    v_mfma_f32_16x16x32_bf16 v[240:243], v[80:83], v[44:47], v[240:243]
    ds_read_b64_tr_b16 v[126:127], v20 offset:22264
    ds_read_b64_tr_b16 v[128:129], v21 offset:21504
    v_mfma_f32_16x16x32_bf16 v[224:227], v[84:87], v[40:43], v[224:227]
    ds_read_b64_tr_b16 v[130:131], v21 offset:22144
    v_mfma_f32_16x16x32_bf16 v[244:247], v[84:87], v[44:47], v[244:247]
    ds_read_b128 v[64:67], v8 offset:16384
    ds_read_b128 v[68:71], v8 offset:18432
    v_mfma_f32_16x16x32_bf16 v[228:231], v[88:91], v[40:43], v[228:231]
    ds_read_b64_tr_b16 v[192:193], v20 offset:26880
    ds_read_b64_tr_b16 v[194:195], v20 offset:27520
    v_mfma_f32_16x16x32_bf16 v[248:251], v[88:91], v[44:47], v[248:251]
    ds_read_b64_tr_b16 v[196:197], v20 offset:26920
    ds_read_b64_tr_b16 v[198:199], v20 offset:27560
    v_mfma_f32_16x16x32_bf16 v[212:215], v[92:95], v[56:59], v[212:215]
    ds_read_b64_tr_b16 v[200:201], v20 offset:26960
    v_mfma_f32_16x16x32_bf16 v[232:235], v[92:95], v[60:63], v[232:235]
    ds_read_b64_tr_b16 v[202:203], v20 offset:27600
    ds_read_b64_tr_b16 v[204:205], v20 offset:27000
    v_mfma_f32_16x16x32_bf16 v[216:219], v[96:99], v[56:59], v[216:219]
    ds_read_b64_tr_b16 v[206:207], v20 offset:27640
    ds_read_b64_tr_b16 v[208:209], v21 offset:26880
    v_mfma_f32_16x16x32_bf16 v[236:239], v[96:99], v[60:63], v[236:239]
    ds_read_b64_tr_b16 v[210:211], v21 offset:27520
    v_mfma_f32_16x16x32_bf16 v[220:223], v[100:103], v[56:59], v[220:223]
    v_mfma_f32_16x16x32_bf16 v[240:243], v[100:103], v[60:63], v[240:243]
    v_mfma_f32_16x16x32_bf16 v[224:227], v[104:107], v[56:59], v[224:227]
    v_mfma_f32_16x16x32_bf16 v[244:247], v[104:107], v[60:63], v[244:247]
    v_mfma_f32_16x16x32_bf16 v[228:231], v[108:111], v[56:59], v[228:231]
    v_mfma_f32_16x16x32_bf16 v[248:251], v[108:111], v[60:63], v[248:251]
    s_waitcnt lgkmcnt(0)
    v_mfma_f32_16x16x32_bf16 v[212:215], v[112:115], v[48:51], v[212:215]
    v_mfma_f32_16x16x32_bf16 v[232:235], v[112:115], v[52:55], v[232:235]
    v_mfma_f32_16x16x32_bf16 v[216:219], v[116:119], v[48:51], v[216:219]
    v_mfma_f32_16x16x32_bf16 v[236:239], v[116:119], v[52:55], v[236:239]
    v_mfma_f32_16x16x32_bf16 v[220:223], v[120:123], v[48:51], v[220:223]
    v_mfma_f32_16x16x32_bf16 v[240:243], v[120:123], v[52:55], v[240:243]
    v_mfma_f32_16x16x32_bf16 v[224:227], v[124:127], v[48:51], v[224:227]
    v_mfma_f32_16x16x32_bf16 v[244:247], v[124:127], v[52:55], v[244:247]
    v_mfma_f32_16x16x32_bf16 v[228:231], v[128:131], v[48:51], v[228:231]
    v_mfma_f32_16x16x32_bf16 v[248:251], v[128:131], v[52:55], v[248:251]
    v_mfma_f32_16x16x32_bf16 v[212:215], v[192:195], v[64:67], v[212:215]
    v_mfma_f32_16x16x32_bf16 v[232:235], v[192:195], v[68:71], v[232:235]
    v_mfma_f32_16x16x32_bf16 v[216:219], v[196:199], v[64:67], v[216:219]
    v_mfma_f32_16x16x32_bf16 v[236:239], v[196:199], v[68:71], v[236:239]
    v_mfma_f32_16x16x32_bf16 v[220:223], v[200:203], v[64:67], v[220:223]
    v_mfma_f32_16x16x32_bf16 v[240:243], v[200:203], v[68:71], v[240:243]
    v_mfma_f32_16x16x32_bf16 v[224:227], v[204:207], v[64:67], v[224:227]
    v_mfma_f32_16x16x32_bf16 v[244:247], v[204:207], v[68:71], v[244:247]
    v_mfma_f32_16x16x32_bf16 v[228:231], v[208:211], v[64:67], v[228:231]
    v_mfma_f32_16x16x32_bf16 v[248:251], v[208:211], v[68:71], v[248:251]
    s_lshl_b32 s62, s52, 2
    s_add_u32 s62, s62, s3
    s_lshl_b32 s62, s62, 3
    s_add_u32 s62, s62, s53
    s_mul_i32 s65, s62, 5120
    s_add_u32 s60, s65, 4096
    s_add_u32 s62, s62, 64
    s_mul_i32 s61, s3, 880
    s_add_u32 s61, s61, 114688
    v_lshl_add_u32 v4, v1, 3, s61
    v_mov_b32 v58, 0
    v_mov_b32 v59, 0
    v_mov_b32 v64, 0
    v_mov_b32 v65, 0
    s_mov_b64 exec, 31
    ds_write_b64 v4, v[58:59] offset:840
    s_mov_b64 exec, -1
    v_pk_mul_f32 v[36:37], v[212:213], s[66:67]
    v_pk_mul_f32 v[38:39], v[214:215], s[66:67]
    v_exp_f32_e64 v36, v36 clamp
    v_exp_f32_e64 v37, v37 clamp
    v_exp_f32_e64 v38, v38 clamp
    v_exp_f32_e64 v39, v39 clamp
    v_max_f32 v212, s64, v212
    v_max_f32 v213, s64, v213
    v_max_f32 v214, s64, v214
    v_max_f32 v215, s64, v215
    v_pk_add_f32 v[212:213], v[212:213], v[36:37]
    v_pk_add_f32 v[214:215], v[214:215], v[38:39]
    v_cvt_pk_bf16_f32 v68, v212, v213
    v_cvt_pk_bf16_f32 v69, v214, v215
    v_pk_mul_f32 v[36:37], v[232:233], s[66:67]
    v_pk_mul_f32 v[38:39], v[234:235], s[66:67]
    v_exp_f32_e64 v36, v36 clamp
    v_exp_f32_e64 v37, v37 clamp
    v_exp_f32_e64 v38, v38 clamp
    v_exp_f32_e64 v39, v39 clamp
    v_max_f32 v232, s64, v232
    v_max_f32 v233, s64, v233
    v_max_f32 v234, s64, v234
    v_max_f32 v235, s64, v235
    v_pk_add_f32 v[232:233], v[232:233], v[36:37]
    v_pk_add_f32 v[234:235], v[234:235], v[38:39]
    v_cvt_pk_bf16_f32 v70, v232, v233
    v_cvt_pk_bf16_f32 v71, v234, v235
    s_nop 1
    v_permlane16_swap_b32 v68, v70
    v_permlane16_swap_b32 v69, v71
    v_pk_mul_f32 v[36:37], v[216:217], s[66:67]
    v_pk_mul_f32 v[38:39], v[218:219], s[66:67]
    v_exp_f32_e64 v36, v36 clamp
    v_exp_f32_e64 v37, v37 clamp
    v_exp_f32_e64 v38, v38 clamp
    v_exp_f32_e64 v39, v39 clamp
    v_max_f32 v216, s64, v216
    v_max_f32 v217, s64, v217
    v_max_f32 v218, s64, v218
    v_max_f32 v219, s64, v219
    v_pk_add_f32 v[216:217], v[216:217], v[36:37]
    v_pk_add_f32 v[218:219], v[218:219], v[38:39]
    v_cvt_pk_bf16_f32 v72, v216, v217
    v_cvt_pk_bf16_f32 v73, v218, v219
    v_pk_mul_f32 v[36:37], v[236:237], s[66:67]
    v_pk_mul_f32 v[38:39], v[238:239], s[66:67]
    v_exp_f32_e64 v36, v36 clamp
    v_exp_f32_e64 v37, v37 clamp
    v_exp_f32_e64 v38, v38 clamp
    v_exp_f32_e64 v39, v39 clamp
    v_max_f32 v236, s64, v236
    v_max_f32 v237, s64, v237
    v_max_f32 v238, s64, v238
    v_max_f32 v239, s64, v239
    v_pk_add_f32 v[236:237], v[236:237], v[36:37]
    v_pk_add_f32 v[238:239], v[238:239], v[38:39]
    v_cvt_pk_bf16_f32 v74, v236, v237
    v_cvt_pk_bf16_f32 v75, v238, v239
    s_nop 1
    v_permlane16_swap_b32 v72, v74
    v_permlane16_swap_b32 v73, v75
    v_pk_mul_f32 v[36:37], v[220:221], s[66:67]
    v_pk_mul_f32 v[38:39], v[222:223], s[66:67]
    v_exp_f32_e64 v36, v36 clamp
    v_exp_f32_e64 v37, v37 clamp
    v_exp_f32_e64 v38, v38 clamp
    v_exp_f32_e64 v39, v39 clamp
    v_max_f32 v220, s64, v220
    v_max_f32 v221, s64, v221
    v_max_f32 v222, s64, v222
    v_max_f32 v223, s64, v223
    v_pk_add_f32 v[220:221], v[220:221], v[36:37]
    v_pk_add_f32 v[222:223], v[222:223], v[38:39]
    v_cvt_pk_bf16_f32 v76, v220, v221
    v_cvt_pk_bf16_f32 v77, v222, v223
    v_pk_mul_f32 v[36:37], v[240:241], s[66:67]
    v_pk_mul_f32 v[38:39], v[242:243], s[66:67]
    v_exp_f32_e64 v36, v36 clamp
    v_exp_f32_e64 v37, v37 clamp
    v_exp_f32_e64 v38, v38 clamp
    v_exp_f32_e64 v39, v39 clamp
    v_max_f32 v240, s64, v240
    v_max_f32 v241, s64, v241
    v_max_f32 v242, s64, v242
    v_max_f32 v243, s64, v243
    v_pk_add_f32 v[240:241], v[240:241], v[36:37]
    v_pk_add_f32 v[242:243], v[242:243], v[38:39]
    v_cvt_pk_bf16_f32 v78, v240, v241
    v_cvt_pk_bf16_f32 v79, v242, v243
    s_nop 1
    v_permlane16_swap_b32 v76, v78
    v_permlane16_swap_b32 v77, v79
    v_pk_mul_f32 v[36:37], v[224:225], s[66:67]
    v_pk_mul_f32 v[38:39], v[226:227], s[66:67]
    v_exp_f32_e64 v36, v36 clamp
    v_exp_f32_e64 v37, v37 clamp
    v_exp_f32_e64 v38, v38 clamp
    v_exp_f32_e64 v39, v39 clamp
    v_max_f32 v224, s64, v224
    v_max_f32 v225, s64, v225
    v_max_f32 v226, s64, v226
    v_max_f32 v227, s64, v227
    v_pk_add_f32 v[224:225], v[224:225], v[36:37]
    v_pk_add_f32 v[226:227], v[226:227], v[38:39]
    v_cvt_pk_bf16_f32 v80, v224, v225
    v_cvt_pk_bf16_f32 v81, v226, v227
    v_pk_mul_f32 v[36:37], v[244:245], s[66:67]
    v_pk_mul_f32 v[38:39], v[246:247], s[66:67]
    v_exp_f32_e64 v36, v36 clamp
    v_exp_f32_e64 v37, v37 clamp
    v_exp_f32_e64 v38, v38 clamp
    v_exp_f32_e64 v39, v39 clamp
    v_max_f32 v244, s64, v244
    v_max_f32 v245, s64, v245
    v_max_f32 v246, s64, v246
    v_max_f32 v247, s64, v247
    v_pk_add_f32 v[244:245], v[244:245], v[36:37]
    v_pk_add_f32 v[246:247], v[246:247], v[38:39]
    v_cvt_pk_bf16_f32 v82, v244, v245
    v_cvt_pk_bf16_f32 v83, v246, v247
    s_nop 1
    v_permlane16_swap_b32 v80, v82
    v_permlane16_swap_b32 v81, v83
    v_pk_mul_f32 v[36:37], v[228:229], s[66:67]
    v_pk_mul_f32 v[38:39], v[230:231], s[66:67]
    v_exp_f32_e64 v36, v36 clamp
    v_exp_f32_e64 v37, v37 clamp
    v_exp_f32_e64 v38, v38 clamp
    v_exp_f32_e64 v39, v39 clamp
    v_max_f32 v228, s64, v228
    v_max_f32 v229, s64, v229
    v_max_f32 v230, s64, v230
    v_max_f32 v231, s64, v231
    v_pk_add_f32 v[228:229], v[228:229], v[36:37]
    v_pk_add_f32 v[230:231], v[230:231], v[38:39]
    v_cvt_pk_bf16_f32 v84, v228, v229
    v_cvt_pk_bf16_f32 v85, v230, v231
    v_pk_mul_f32 v[36:37], v[248:249], s[66:67]
    v_pk_mul_f32 v[38:39], v[250:251], s[66:67]
    v_exp_f32_e64 v36, v36 clamp
    v_exp_f32_e64 v37, v37 clamp
    v_exp_f32_e64 v38, v38 clamp
    v_exp_f32_e64 v39, v39 clamp
    v_max_f32 v248, s64, v248
    v_max_f32 v249, s64, v249
    v_max_f32 v250, s64, v250
    v_max_f32 v251, s64, v251
    v_pk_add_f32 v[248:249], v[248:249], v[36:37]
    v_pk_add_f32 v[250:251], v[250:251], v[38:39]
    v_cvt_pk_bf16_f32 v86, v248, v249
    v_cvt_pk_bf16_f32 v87, v250, v251
    s_nop 1
    v_permlane16_swap_b32 v84, v86
    v_permlane16_swap_b32 v85, v87
    s_mov_b32 s69, 0x41800000
    s_mov_b32 s70, 0x88888888
    s_mov_b32 s71, 0x88888888
    s_mov_b32 s74, 400000
    s_waitcnt vmcnt(0)
kvf_48:
    buffer_load_dwordx4 v[96:99], v31, s[32:35], 0 offen offset:0 sc1
    buffer_load_dwordx4 v[100:103], v31, s[32:35], 0 offen offset:1024 sc1
    buffer_load_dwordx4 v[104:107], v31, s[32:35], 0 offen offset:2048 sc1
kvv_49:
    s_waitcnt vmcnt(0)
    v_min_f32 v4, v96, v100
    v_cmp_neq_f32 s[4:5], s69, v104
    v_cmp_neq_f32 vcc, s69, v4
    s_sub_u32 s74, s74, 1
    s_cbranch_scc1 kvd_50
    s_and_b32 s4, s4, 0x888
    s_and_b64 vcc, vcc, s[70:71]
    s_or_b32 vcc_lo, vcc_lo, s4
    s_cmp_eq_u64 vcc, 0
    s_cbranch_scc1 kvd_50
    s_sleep 2
    s_branch kvf_48
kvd_50:
    v_cvt_pk_bf16_f32 v96, v96, v97
    v_cvt_pk_bf16_f32 v97, v98, v99
    v_cvt_pk_bf16_f32 v100, v100, v101
    v_cvt_pk_bf16_f32 v101, v102, v103
    v_cvt_pk_bf16_f32 v104, v104, v105
    v_cvt_pk_bf16_f32 v105, v106, v107
    s_mov_b32 exec_lo, 0x77777777
    s_mov_b32 exec_hi, 0x77777777
    ds_write_b64 v32, v[96:97] offset:0
    ds_write_b64 v32, v[100:101] offset:384
    s_mov_b64 exec, 0x777
    ds_write_b64 v32, v[104:105] offset:768
    s_mov_b64 exec, -1
    s_waitcnt lgkmcnt(0)
    s_barrier
    ds_read_b64 v[56:57], v25 offset:0
    ds_read_b64 v[40:41], v24 offset:0
    ds_read_b64 v[42:43], v24 offset:8
    ds_read_b64 v[60:61], v25 offset:880
    ds_read_b64 v[44:45], v24 offset:880
    ds_read_b64 v[46:47], v24 offset:888
    ds_read_b64 v[62:63], v26 offset:1760
    ds_read_b64 v[48:49], v24 offset:1760
    ds_read_b64 v[50:51], v24 offset:1768
    ds_read_b64 v[66:67], v26 offset:2640
    ds_read_b64 v[52:53], v24 offset:2640
    ds_read_b64 v[54:55], v24 offset:2648
    s_waitcnt lgkmcnt(9)
    v_mfma_f32_32x32x16_bf16 v[148:163], v[56:59], v[84:87], 0
    s_nop 0
    v_mfma_f32_32x32x16_bf16 v[148:163], v[40:43], v[68:71], v[148:163]
    s_waitcnt lgkmcnt(6)
    v_mfma_f32_32x32x16_bf16 v[164:179], v[58:61], v[84:87], 0
    s_nop 0
    v_mfma_f32_32x32x16_bf16 v[164:179], v[44:47], v[72:75], v[164:179]
    s_waitcnt lgkmcnt(3)
    v_mfma_f32_32x32x16_bf16 v[180:195], v[62:65], v[84:87], 0
    s_nop 0
    v_mfma_f32_32x32x16_bf16 v[180:195], v[48:51], v[76:79], v[180:195]
    s_waitcnt lgkmcnt(0)
    s_nop 3
    v_add_f32 v92, s64, v158
    v_rcp_f32 v92, v92
    s_nop 0
    v_mul_f32 v148, v148, v92
    v_mul_f32 v149, v149, v92
    v_mul_f32 v150, v150, v92
    v_mfma_f32_32x32x16_bf16 v[196:211], v[64:67], v[84:87], 0
    v_mul_f32 v151, v151, v92
    v_mul_f32 v152, v152, v92
    v_mul_f32 v153, v153, v92
    v_mul_f32 v154, v154, v92
    v_mul_f32 v155, v155, v92
    v_mul_f32 v156, v156, v92
    v_mfma_f32_32x32x16_bf16 v[196:211], v[52:55], v[80:83], v[196:211]
    v_mul_f32 v157, v157, v92
    v_cvt_pk_bf16_f32 v68, v148, v149
    v_cvt_pk_bf16_f32 v69, v150, v151
    v_cvt_pk_bf16_f32 v70, v152, v153
    v_cvt_pk_bf16_f32 v71, v154, v155
    buffer_store_dwordx4 v[68:71], v31, s[36:39], s65 offen offset:0 sc1
    v_cvt_pk_bf16_f32 v88, v156, v157
    v_add_f32 v92, s64, v174
    v_rcp_f32 v92, v92
    s_nop 0
    v_mul_f32 v164, v164, v92
    v_mul_f32 v165, v165, v92
    v_mul_f32 v166, v166, v92
    v_mul_f32 v167, v167, v92
    v_mul_f32 v168, v168, v92
    v_mul_f32 v169, v169, v92
    v_mul_f32 v170, v170, v92
    v_mul_f32 v171, v171, v92
    v_mul_f32 v172, v172, v92
    v_mul_f32 v173, v173, v92
    v_cvt_pk_bf16_f32 v72, v164, v165
    v_cvt_pk_bf16_f32 v73, v166, v167
    v_cvt_pk_bf16_f32 v74, v168, v169
    v_cvt_pk_bf16_f32 v75, v170, v171
    buffer_store_dwordx4 v[72:75], v31, s[36:39], s65 offen offset:1024 sc1
    v_cvt_pk_bf16_f32 v89, v172, v173
    v_add_f32 v92, s64, v190
    v_rcp_f32 v92, v92
    s_nop 0
    v_mul_f32 v180, v180, v92
    v_mul_f32 v181, v181, v92
    v_mul_f32 v182, v182, v92
    v_mul_f32 v183, v183, v92
    v_mul_f32 v184, v184, v92
    v_mul_f32 v185, v185, v92
    v_mul_f32 v186, v186, v92
    v_mul_f32 v187, v187, v92
    v_mul_f32 v188, v188, v92
    v_mul_f32 v189, v189, v92
    v_cvt_pk_bf16_f32 v76, v180, v181
    v_cvt_pk_bf16_f32 v77, v182, v183
    v_cvt_pk_bf16_f32 v78, v184, v185
    v_cvt_pk_bf16_f32 v79, v186, v187
    buffer_store_dwordx4 v[76:79], v31, s[36:39], s65 offen offset:2048 sc1
    v_cvt_pk_bf16_f32 v90, v188, v189
    v_add_f32 v92, s64, v206
    v_rcp_f32 v92, v92
    s_nop 0
    v_mul_f32 v196, v196, v92
    v_mul_f32 v197, v197, v92
    v_mul_f32 v198, v198, v92
    v_mul_f32 v199, v199, v92
    v_mul_f32 v200, v200, v92
    v_mul_f32 v201, v201, v92
    v_mul_f32 v202, v202, v92
    v_mul_f32 v203, v203, v92
    v_mul_f32 v204, v204, v92
    v_mul_f32 v205, v205, v92
    v_cvt_pk_bf16_f32 v80, v196, v197
    v_cvt_pk_bf16_f32 v81, v198, v199
    v_cvt_pk_bf16_f32 v82, v200, v201
    v_cvt_pk_bf16_f32 v83, v202, v203
    buffer_store_dwordx4 v[80:83], v31, s[36:39], s65 offen offset:3072 sc1
    v_cvt_pk_bf16_f32 v91, v204, v205
    buffer_store_dwordx4 v[88:91], v31, s[36:39], s60 offen sc1
    s_branch L_G2
L_WO:
    s_mov_b32 s32, s24
    s_mov_b32 s33, s25
    s_mov_b32 s34, 819200
    s_mov_b32 s35, 0x20000
    v_lshrrev_b32 v228, 3, v1
    v_mul_u32_u24 v228, 1280, v228
    v_and_b32 v229, 7, v1
    v_lshrrev_b32 v230, 4, v1
    v_lshlrev_b32 v230, 1, v230
    v_xor_b32 v229, v229, v230
    v_lshl_add_u32 v231, v229, 4, v228
    v_add_u32 v232, 9216, v231
    v_add_u32 v233, 18432, v231
    v_add_u32 v234, 27648, v231
    s_sub_u32 s69, s3, 4
    s_mul_i32 s68, s69, 204800
    s_lshl_b32 s70, s54, 7
    s_add_u32 s68, s68, s70
    s_mul_i32 s69, s69, 20480
    s_add_u32 s69, s69, 32768
    s_add_u32 m0, s69, 0
    s_nop 0
    buffer_load_dwordx4 v231, s[32:35], s68 offen offset:0 lds
    buffer_load_dwordx4 v232, s[32:35], s68 offen offset:1024 lds
    buffer_load_dwordx4 v233, s[32:35], s68 offen offset:2048 lds
    buffer_load_dwordx4 v234, s[32:35], s68 offen offset:3072 lds
    s_add_u32 s68, s68, 40960
    s_add_u32 m0, s69, 4096
    s_nop 0
    buffer_load_dwordx4 v231, s[32:35], s68 offen offset:0 lds
    buffer_load_dwordx4 v232, s[32:35], s68 offen offset:1024 lds
    buffer_load_dwordx4 v233, s[32:35], s68 offen offset:2048 lds
    buffer_load_dwordx4 v234, s[32:35], s68 offen offset:3072 lds
    s_add_u32 s68, s68, 40960
    s_add_u32 m0, s69, 8192
    s_nop 0
    buffer_load_dwordx4 v231, s[32:35], s68 offen offset:0 lds
    buffer_load_dwordx4 v232, s[32:35], s68 offen offset:1024 lds
    buffer_load_dwordx4 v233, s[32:35], s68 offen offset:2048 lds
    buffer_load_dwordx4 v234, s[32:35], s68 offen offset:3072 lds
    s_add_u32 s68, s68, 40960
    s_add_u32 m0, s69, 12288
    s_nop 0
    buffer_load_dwordx4 v231, s[32:35], s68 offen offset:0 lds
    buffer_load_dwordx4 v232, s[32:35], s68 offen offset:1024 lds
    buffer_load_dwordx4 v233, s[32:35], s68 offen offset:2048 lds
    buffer_load_dwordx4 v234, s[32:35], s68 offen offset:3072 lds
    s_add_u32 s68, s68, 40960
    s_add_u32 m0, s69, 16384
    s_nop 0
    buffer_load_dwordx4 v231, s[32:35], s68 offen offset:0 lds
    buffer_load_dwordx4 v232, s[32:35], s68 offen offset:1024 lds
    buffer_load_dwordx4 v233, s[32:35], s68 offen offset:2048 lds
    buffer_load_dwordx4 v234, s[32:35], s68 offen offset:3072 lds
    s_add_u32 s68, s68, 40960
    s_add_u32 s36, s30, 2621440
    s_addc_u32 s37, s31, 0
    s_mov_b32 s38, 2621440
    s_mov_b32 s39, 0x20000
    s_setpc_b64 s[72:73]
L_G2:
    s_mul_i32 s60, s54, 0
    s_add_u32 s60, s60, s3
    s_and_b32 s60, s60, 7
    s_lshl_b32 s62, s52, 3
    s_add_u32 s62, s62, s60
    s_mul_i32 s63, s62, 40960
    s_lshr_b32 s62, s62, 1
    s_lshl_b32 s62, s62, 3
    s_mul_i32 s65, s62, 5120
    s_add_u32 s62, s62, 64
    v_and_b32 v2, 7, v1
    v_add_u32 v9, s62, v2
    v_lshlrev_b32 v9, 7, v9
    v_lshrrev_b32 v6, 4, v1
    v_and_b32 v2, 15, v1
    v_and_b32 v3, 1, v6
    v_lshrrev_b32 v4, 1, v6
    v_and_b32 v10, 7, v2
    v_mul_u32_u24 v10, 2560, v10
    v_and_b32 v5, 8, v2
    v_lshl_add_u32 v10, v5, 3, v10
    v_lshl_add_u32 v10, v3, 5, v10
    v_lshl_add_u32 v10, v4, 4, v10
    s_and_b32 s62, s60, 1
    s_lshl_b32 s62, s62, 8
    v_lshl_add_u32 v5, v2, 4, s62
    v_lshl_add_u32 v5, v3, 9, v5
    v_lshl_add_u32 v7, v4, 10, v5
    v_mul_u32_u24 v8, 5120, v4
    v_add_u32 v8, v8, v5
    v_add_u32 v8, 4096, v8
    s_lshl_b32 s62, s54, 7
    s_add_u32 s63, s63, s62
    s_add_u32 s63, s63, 1280
    v_and_b32 v5, 3, v1
    v_lshlrev_b32 v5, 3, v5
    s_and_b32 s64, s54, 3
    s_mul_i32 s62, s64, 20480
    s_add_u32 s62, s62, 32768
    v_add_u32 v5, s62, v5
    s_movk_i32 s71, 20480
    s_cmp_eq_u32 s64, 3
    s_cselect_b32 s68, -61440, s71
    s_cmp_eq_u32 s64, 2
    s_cselect_b32 s69, -61440, s71
    s_cmp_eq_u32 s64, 1
    s_cselect_b32 s70, -61440, s71
    v_lshrrev_b32 v2, 2, v2
    v_mul_u32_u24 v12, 20, v4
    v_lshl_add_u32 v12, v3, 2, v12
    v_add_u32 v12, v12, v2
    v_lshl_add_u32 v11, v12, 7, v5
    v_bfe_u32 v12, v12, 1, 2
    v_lshl_add_u32 v11, v12, 5, v11
    v_mul_u32_u24 v16, 80, v4
    v_lshl_add_u32 v16, v3, 1, v16
    v_lshrrev_b32 v17, 1, v2
    v_mul_u32_u24 v17, 20, v17
    v_and_b32 v2, 1, v2
    v_add3_u32 v16, v16, v17, v2
    v_add_u32 v16, 16, v16
    v_lshl_add_u32 v15, v16, 7, v5
    v_bfe_u32 v16, v16, 1, 2
    v_lshl_add_u32 v15, v16, 5, v15
    v_xor_b32 v12, 32, v11
    v_xor_b32 v16, 32, v15
    v_xor_b32 v13, 64, v11
    v_xor_b32 v17, 64, v15
    v_xor_b32 v14, 96, v11
    v_xor_b32 v18, 96, v15
    s_mov_b32 s44, s26
    s_mov_b32 s45, s27
    s_mov_b32 s46, 5242880
    s_mov_b32 s47, 0x20000
    ds_read_b64_tr_b16 v[52:53], v11 offset:0
    ds_read_b64_tr_b16 v[54:55], v11 offset:1024
    ds_read_b64_tr_b16 v[56:57], v12 offset:0
    ds_read_b64_tr_b16 v[58:59], v12 offset:1024
    ds_read_b64_tr_b16 v[60:61], v13 offset:0
    ds_read_b64_tr_b16 v[62:63], v13 offset:1024
    ds_read_b64_tr_b16 v[64:65], v14 offset:0
    ds_read_b64_tr_b16 v[66:67], v14 offset:1024
    ds_read_b64_tr_b16 v[68:69], v11 offset:5120
    ds_read_b64_tr_b16 v[70:71], v11 offset:6144
    ds_read_b64_tr_b16 v[72:73], v12 offset:5120
    ds_read_b64_tr_b16 v[74:75], v12 offset:6144
    ds_read_b64_tr_b16 v[76:77], v13 offset:5120
    ds_read_b64_tr_b16 v[78:79], v13 offset:6144
    ds_read_b64_tr_b16 v[80:81], v14 offset:5120
    ds_read_b64_tr_b16 v[82:83], v14 offset:6144
    ds_read_b64_tr_b16 v[84:85], v11 offset:10240
    ds_read_b64_tr_b16 v[86:87], v11 offset:11264
    ds_read_b64_tr_b16 v[88:89], v12 offset:10240
    ds_read_b64_tr_b16 v[90:91], v12 offset:11264
    ds_read_b64_tr_b16 v[92:93], v13 offset:10240
    ds_read_b64_tr_b16 v[94:95], v13 offset:11264
    ds_read_b64_tr_b16 v[96:97], v14 offset:10240
    ds_read_b64_tr_b16 v[98:99], v14 offset:11264
    ds_read_b64_tr_b16 v[100:101], v11 offset:15360
    ds_read_b64_tr_b16 v[102:103], v11 offset:16384
    ds_read_b64_tr_b16 v[104:105], v12 offset:15360
    ds_read_b64_tr_b16 v[106:107], v12 offset:16384
    ds_read_b64_tr_b16 v[108:109], v13 offset:15360
    ds_read_b64_tr_b16 v[110:111], v13 offset:16384
    ds_read_b64_tr_b16 v[112:113], v14 offset:15360
    ds_read_b64_tr_b16 v[114:115], v14 offset:16384
    s_cmp_ge_u32 s59, 16
    s_cbranch_scc1 npub_51
    s_lshl_b32 s60, s52, 3
    s_add_u32 s60, s60, s53
    s_add_u32 s60, s60, 64
    s_waitcnt vmcnt(0)
    s_barrier
    s_cmp_lg_u32 s3, 5
    s_cbranch_scc1 nofl_52
    s_lshl_b32 s74, s60, 7
    v_mov_b32 v2, 0
    v_mov_b32 v3, 1
    s_mov_b64 exec, 1
    buffer_store_dword v3, v2, s[48:51], s74 offen sc1
    s_mov_b64 exec, -1
nofl_52:
npub_51:
    ds_read_b64_tr_b16 v[116:117], v15 offset:0
    ds_read_b64_tr_b16 v[118:119], v15 offset:5120
    ds_read_b64_tr_b16 v[120:121], v16 offset:0
    ds_read_b64_tr_b16 v[122:123], v16 offset:5120
    ds_read_b64_tr_b16 v[124:125], v17 offset:0
    ds_read_b64_tr_b16 v[126:127], v17 offset:5120
    ds_read_b64_tr_b16 v[128:129], v18 offset:0
    ds_read_b64_tr_b16 v[130:131], v18 offset:5120
    v_add_u32 v11, s68, v11
    v_add_u32 v12, s68, v12
    v_add_u32 v13, s68, v13
    v_add_u32 v14, s68, v14
    v_add_u32 v15, s68, v15
    v_add_u32 v16, s68, v16
    v_add_u32 v17, s68, v17
    v_add_u32 v18, s68, v18
    ds_read_b64_tr_b16 v[132:133], v11 offset:0
    ds_read_b64_tr_b16 v[134:135], v11 offset:1024
    ds_read_b64_tr_b16 v[136:137], v12 offset:0
    ds_read_b64_tr_b16 v[138:139], v12 offset:1024
    ds_read_b64_tr_b16 v[140:141], v13 offset:0
    ds_read_b64_tr_b16 v[142:143], v13 offset:1024
    ds_read_b64_tr_b16 v[144:145], v14 offset:0
    ds_read_b64_tr_b16 v[146:147], v14 offset:1024
    ds_read_b64_tr_b16 v[148:149], v11 offset:5120
    ds_read_b64_tr_b16 v[150:151], v11 offset:6144
    ds_read_b64_tr_b16 v[152:153], v12 offset:5120
    ds_read_b64_tr_b16 v[154:155], v12 offset:6144
    ds_read_b64_tr_b16 v[156:157], v13 offset:5120
    ds_read_b64_tr_b16 v[158:159], v13 offset:6144
    ds_read_b64_tr_b16 v[160:161], v14 offset:5120
    ds_read_b64_tr_b16 v[162:163], v14 offset:6144
    ds_read_b64_tr_b16 v[164:165], v11 offset:10240
    ds_read_b64_tr_b16 v[166:167], v11 offset:11264
    ds_read_b64_tr_b16 v[168:169], v12 offset:10240
    ds_read_b64_tr_b16 v[170:171], v12 offset:11264
    ds_read_b64_tr_b16 v[172:173], v13 offset:10240
    ds_read_b64_tr_b16 v[174:175], v13 offset:11264
    ds_read_b64_tr_b16 v[176:177], v14 offset:10240
    ds_read_b64_tr_b16 v[178:179], v14 offset:11264
    ds_read_b64_tr_b16 v[180:181], v11 offset:15360
    ds_read_b64_tr_b16 v[182:183], v11 offset:16384
    ds_read_b64_tr_b16 v[184:185], v12 offset:15360
    ds_read_b64_tr_b16 v[186:187], v12 offset:16384
    ds_read_b64_tr_b16 v[188:189], v13 offset:15360
    ds_read_b64_tr_b16 v[190:191], v13 offset:16384
    ds_read_b64_tr_b16 v[192:193], v14 offset:15360
    ds_read_b64_tr_b16 v[194:195], v14 offset:16384
    ds_read_b64_tr_b16 v[196:197], v15 offset:0
    ds_read_b64_tr_b16 v[198:199], v15 offset:5120
    ds_read_b64_tr_b16 v[200:201], v16 offset:0
    ds_read_b64_tr_b16 v[202:203], v16 offset:5120
    ds_read_b64_tr_b16 v[204:205], v17 offset:0
    ds_read_b64_tr_b16 v[206:207], v17 offset:5120
    ds_read_b64_tr_b16 v[208:209], v18 offset:0
    ds_read_b64_tr_b16 v[210:211], v18 offset:5120
    v_add_u32 v11, s69, v11
    v_add_u32 v12, s69, v12
    v_add_u32 v13, s69, v13
    v_add_u32 v14, s69, v14
    v_add_u32 v15, s69, v15
    v_add_u32 v16, s69, v16
    v_add_u32 v17, s69, v17
    v_add_u32 v18, s69, v18
    s_cmp_lg_u32 s3, 4
    s_cbranch_scc1 g2nw_53
    s_lshl_b32 s62, s52, 3
    s_add_u32 s62, s62, 64
    v_and_b32 v9, 7, v1
    v_add_u32 v9, s62, v9
    v_lshlrev_b32 v9, 7, v9
    s_cmp_lt_u32 s59, 16
    s_cbranch_scc1 nj1_54
    s_mov_b64 exec, 0x80
    s_mov_b32 s74, 400000
poll_55:
    buffer_load_dword v2, v9, s[48:51], 0 offen sc1
    s_waitcnt vmcnt(0)
    v_cmp_ne_u32 vcc, 1, v2
    s_sub_u32 s74, s74, 1
    s_cbranch_scc1 polld_56
    s_cmp_eq_u64 vcc, 0
    s_cbranch_scc1 polld_56
    s_sleep 4
    s_branch poll_55
polld_56:
    s_mov_b64 exec, -1
nj1_54:
    s_mov_b32 s74, 400000
poll_57:
    buffer_load_dword v2, v9, s[48:51], 0 offen sc1
    s_waitcnt vmcnt(0)
    v_cmp_ne_u32 vcc, 1, v2
    s_sub_u32 s74, s74, 1
    s_cbranch_scc1 polld_58
    s_cmp_eq_u64 vcc, 0
    s_cbranch_scc1 polld_58
    s_sleep 1
    s_branch poll_57
polld_58:
g2nw_53:
    s_barrier
    s_add_u32 s66, s64, 0
    s_and_b32 s66, s66, 3
    s_mul_i32 s66, s66, 10240
    s_add_u32 s66, s66, s65
    s_add_u32 s67, s66, 5120
    buffer_load_dwordx4 v[20:23], v7, s[36:39], s66 offen offset:0 sc1
    buffer_load_dwordx4 v[24:27], v7, s[36:39], s66 offen offset:2048 sc1
    buffer_load_dwordx4 v[28:31], v7, s[36:39], s67 offen offset:0 sc1
    buffer_load_dwordx4 v[32:35], v7, s[36:39], s67 offen offset:2048 sc1
    buffer_load_dwordx4 v[36:39], v8, s[36:39], s66 offen sc1
    s_add_u32 s66, s64, 1
    s_and_b32 s66, s66, 3
    s_mul_i32 s66, s66, 10240
    s_add_u32 s66, s66, s65
    s_add_u32 s67, s66, 5120
    buffer_load_dwordx4 v[40:43], v7, s[36:39], s66 offen offset:0 sc1
    s_waitcnt lgkmcnt(0)
    s_waitcnt vmcnt(5) lgkmcnt(15)
    s_setprio 3
    v_mfma_f32_16x16x32_bf16 v[228:231], v[52:55], v[20:23], 0
    ds_read_b64_tr_b16 v[212:213], v11 offset:0
    ds_read_b64_tr_b16 v[214:215], v11 offset:1024
    v_mfma_f32_16x16x32_bf16 v[232:235], v[56:59], v[20:23], 0
    ds_read_b64_tr_b16 v[216:217], v12 offset:0
    ds_read_b64_tr_b16 v[218:219], v12 offset:1024
    v_mfma_f32_16x16x32_bf16 v[236:239], v[60:63], v[20:23], 0
    ds_read_b64_tr_b16 v[220:221], v13 offset:0
    ds_read_b64_tr_b16 v[222:223], v13 offset:1024
    v_mfma_f32_16x16x32_bf16 v[240:243], v[64:67], v[20:23], 0
    ds_read_b64_tr_b16 v[224:225], v14 offset:0
    ds_read_b64_tr_b16 v[226:227], v14 offset:1024
    buffer_load_dwordx4 v[44:47], v7, s[36:39], s66 offen offset:2048 sc1
    s_waitcnt vmcnt(5) lgkmcnt(15)
    v_mfma_f32_16x16x32_bf16 v[228:231], v[68:71], v[24:27], v[228:231]
    ds_read_b64_tr_b16 v[52:53], v11 offset:5120
    ds_read_b64_tr_b16 v[54:55], v11 offset:6144
    v_mfma_f32_16x16x32_bf16 v[232:235], v[72:75], v[24:27], v[232:235]
    ds_read_b64_tr_b16 v[56:57], v12 offset:5120
    ds_read_b64_tr_b16 v[58:59], v12 offset:6144
    v_mfma_f32_16x16x32_bf16 v[236:239], v[76:79], v[24:27], v[236:239]
    ds_read_b64_tr_b16 v[60:61], v13 offset:5120
    ds_read_b64_tr_b16 v[62:63], v13 offset:6144
    v_mfma_f32_16x16x32_bf16 v[240:243], v[80:83], v[24:27], v[240:243]
    ds_read_b64_tr_b16 v[64:65], v14 offset:5120
    ds_read_b64_tr_b16 v[66:67], v14 offset:6144
    buffer_load_dwordx4 v[48:51], v7, s[36:39], s67 offen offset:0 sc1
    s_waitcnt vmcnt(5) lgkmcnt(15)
    v_mfma_f32_16x16x32_bf16 v[228:231], v[84:87], v[28:31], v[228:231]
    ds_read_b64_tr_b16 v[68:69], v11 offset:10240
    ds_read_b64_tr_b16 v[70:71], v11 offset:11264
    v_mfma_f32_16x16x32_bf16 v[232:235], v[88:91], v[28:31], v[232:235]
    ds_read_b64_tr_b16 v[72:73], v12 offset:10240
    ds_read_b64_tr_b16 v[74:75], v12 offset:11264
    v_mfma_f32_16x16x32_bf16 v[236:239], v[92:95], v[28:31], v[236:239]
    ds_read_b64_tr_b16 v[76:77], v13 offset:10240
    ds_read_b64_tr_b16 v[78:79], v13 offset:11264
    v_mfma_f32_16x16x32_bf16 v[240:243], v[96:99], v[28:31], v[240:243]
    ds_read_b64_tr_b16 v[80:81], v14 offset:10240
    ds_read_b64_tr_b16 v[82:83], v14 offset:11264
    buffer_load_dwordx4 v[20:23], v7, s[36:39], s67 offen offset:2048 sc1
    s_waitcnt vmcnt(5) lgkmcnt(15)
    v_mfma_f32_16x16x32_bf16 v[228:231], v[100:103], v[32:35], v[228:231]
    ds_read_b64_tr_b16 v[84:85], v11 offset:15360
    ds_read_b64_tr_b16 v[86:87], v11 offset:16384
    v_mfma_f32_16x16x32_bf16 v[232:235], v[104:107], v[32:35], v[232:235]
    ds_read_b64_tr_b16 v[88:89], v12 offset:15360
    ds_read_b64_tr_b16 v[90:91], v12 offset:16384
    v_mfma_f32_16x16x32_bf16 v[236:239], v[108:111], v[32:35], v[236:239]
    ds_read_b64_tr_b16 v[92:93], v13 offset:15360
    ds_read_b64_tr_b16 v[94:95], v13 offset:16384
    v_mfma_f32_16x16x32_bf16 v[240:243], v[112:115], v[32:35], v[240:243]
    ds_read_b64_tr_b16 v[96:97], v14 offset:15360
    ds_read_b64_tr_b16 v[98:99], v14 offset:16384
    buffer_load_dwordx4 v[24:27], v8, s[36:39], s66 offen sc1
    s_waitcnt vmcnt(5) lgkmcnt(15)
    v_mfma_f32_16x16x32_bf16 v[228:231], v[116:119], v[36:39], v[228:231]
    ds_read_b64_tr_b16 v[100:101], v15 offset:0
    ds_read_b64_tr_b16 v[102:103], v15 offset:5120
    v_mfma_f32_16x16x32_bf16 v[232:235], v[120:123], v[36:39], v[232:235]
    ds_read_b64_tr_b16 v[104:105], v16 offset:0
    ds_read_b64_tr_b16 v[106:107], v16 offset:5120
    v_mfma_f32_16x16x32_bf16 v[236:239], v[124:127], v[36:39], v[236:239]
    ds_read_b64_tr_b16 v[108:109], v17 offset:0
    ds_read_b64_tr_b16 v[110:111], v17 offset:5120
    v_mfma_f32_16x16x32_bf16 v[240:243], v[128:131], v[36:39], v[240:243]
    ds_read_b64_tr_b16 v[112:113], v18 offset:0
    ds_read_b64_tr_b16 v[114:115], v18 offset:5120
    v_add_u32 v11, s70, v11
    v_add_u32 v12, s70, v12
    v_add_u32 v13, s70, v13
    v_add_u32 v14, s70, v14
    v_add_u32 v15, s70, v15
    v_add_u32 v16, s70, v16
    v_add_u32 v17, s70, v17
    v_add_u32 v18, s70, v18
    s_add_u32 s66, s64, 2
    s_and_b32 s66, s66, 3
    s_mul_i32 s66, s66, 10240
    s_add_u32 s66, s66, s65
    s_add_u32 s67, s66, 5120
    buffer_load_dwordx4 v[28:31], v7, s[36:39], s66 offen offset:0 sc1
    s_waitcnt vmcnt(5) lgkmcnt(15)
    s_setprio 2
    v_mfma_f32_16x16x32_bf16 v[228:231], v[132:135], v[40:43], v[228:231]
    ds_read_b64_tr_b16 v[116:117], v11 offset:0
    ds_read_b64_tr_b16 v[118:119], v11 offset:1024
    v_mfma_f32_16x16x32_bf16 v[232:235], v[136:139], v[40:43], v[232:235]
    ds_read_b64_tr_b16 v[120:121], v12 offset:0
    ds_read_b64_tr_b16 v[122:123], v12 offset:1024
    v_mfma_f32_16x16x32_bf16 v[236:239], v[140:143], v[40:43], v[236:239]
    ds_read_b64_tr_b16 v[124:125], v13 offset:0
    ds_read_b64_tr_b16 v[126:127], v13 offset:1024
    v_mfma_f32_16x16x32_bf16 v[240:243], v[144:147], v[40:43], v[240:243]
    ds_read_b64_tr_b16 v[128:129], v14 offset:0
    ds_read_b64_tr_b16 v[130:131], v14 offset:1024
    buffer_load_dwordx4 v[32:35], v7, s[36:39], s66 offen offset:2048 sc1
    s_waitcnt vmcnt(5) lgkmcnt(15)
    v_mfma_f32_16x16x32_bf16 v[228:231], v[148:151], v[44:47], v[228:231]
    ds_read_b64_tr_b16 v[132:133], v11 offset:5120
    ds_read_b64_tr_b16 v[134:135], v11 offset:6144
    v_mfma_f32_16x16x32_bf16 v[232:235], v[152:155], v[44:47], v[232:235]
    ds_read_b64_tr_b16 v[136:137], v12 offset:5120
    ds_read_b64_tr_b16 v[138:139], v12 offset:6144
    v_mfma_f32_16x16x32_bf16 v[236:239], v[156:159], v[44:47], v[236:239]
    ds_read_b64_tr_b16 v[140:141], v13 offset:5120
    ds_read_b64_tr_b16 v[142:143], v13 offset:6144
    v_mfma_f32_16x16x32_bf16 v[240:243], v[160:163], v[44:47], v[240:243]
    ds_read_b64_tr_b16 v[144:145], v14 offset:5120
    ds_read_b64_tr_b16 v[146:147], v14 offset:6144
    buffer_load_dwordx4 v[36:39], v7, s[36:39], s67 offen offset:0 sc1
    s_waitcnt vmcnt(5) lgkmcnt(15)
    v_mfma_f32_16x16x32_bf16 v[228:231], v[164:167], v[48:51], v[228:231]
    ds_read_b64_tr_b16 v[148:149], v11 offset:10240
    ds_read_b64_tr_b16 v[150:151], v11 offset:11264
    v_mfma_f32_16x16x32_bf16 v[232:235], v[168:171], v[48:51], v[232:235]
    ds_read_b64_tr_b16 v[152:153], v12 offset:10240
    ds_read_b64_tr_b16 v[154:155], v12 offset:11264
    v_mfma_f32_16x16x32_bf16 v[236:239], v[172:175], v[48:51], v[236:239]
    ds_read_b64_tr_b16 v[156:157], v13 offset:10240
    ds_read_b64_tr_b16 v[158:159], v13 offset:11264
    v_mfma_f32_16x16x32_bf16 v[240:243], v[176:179], v[48:51], v[240:243]
    ds_read_b64_tr_b16 v[160:161], v14 offset:10240
    ds_read_b64_tr_b16 v[162:163], v14 offset:11264
    buffer_load_dwordx4 v[40:43], v7, s[36:39], s67 offen offset:2048 sc1
    s_waitcnt vmcnt(5) lgkmcnt(15)
    v_mfma_f32_16x16x32_bf16 v[228:231], v[180:183], v[20:23], v[228:231]
    ds_read_b64_tr_b16 v[164:165], v11 offset:15360
    ds_read_b64_tr_b16 v[166:167], v11 offset:16384
    v_mfma_f32_16x16x32_bf16 v[232:235], v[184:187], v[20:23], v[232:235]
    ds_read_b64_tr_b16 v[168:169], v12 offset:15360
    ds_read_b64_tr_b16 v[170:171], v12 offset:16384
    v_mfma_f32_16x16x32_bf16 v[236:239], v[188:191], v[20:23], v[236:239]
    ds_read_b64_tr_b16 v[172:173], v13 offset:15360
    ds_read_b64_tr_b16 v[174:175], v13 offset:16384
    v_mfma_f32_16x16x32_bf16 v[240:243], v[192:195], v[20:23], v[240:243]
    ds_read_b64_tr_b16 v[176:177], v14 offset:15360
    ds_read_b64_tr_b16 v[178:179], v14 offset:16384
    buffer_load_dwordx4 v[44:47], v8, s[36:39], s66 offen sc1
    s_waitcnt vmcnt(5) lgkmcnt(15)
    v_mfma_f32_16x16x32_bf16 v[228:231], v[196:199], v[24:27], v[228:231]
    ds_read_b64_tr_b16 v[180:181], v15 offset:0
    ds_read_b64_tr_b16 v[182:183], v15 offset:5120
    v_mfma_f32_16x16x32_bf16 v[232:235], v[200:203], v[24:27], v[232:235]
    ds_read_b64_tr_b16 v[184:185], v16 offset:0
    ds_read_b64_tr_b16 v[186:187], v16 offset:5120
    v_mfma_f32_16x16x32_bf16 v[236:239], v[204:207], v[24:27], v[236:239]
    ds_read_b64_tr_b16 v[188:189], v17 offset:0
    ds_read_b64_tr_b16 v[190:191], v17 offset:5120
    v_mfma_f32_16x16x32_bf16 v[240:243], v[208:211], v[24:27], v[240:243]
    ds_read_b64_tr_b16 v[192:193], v18 offset:0
    ds_read_b64_tr_b16 v[194:195], v18 offset:5120
    s_add_u32 s66, s64, 3
    s_and_b32 s66, s66, 3
    s_mul_i32 s66, s66, 10240
    s_add_u32 s66, s66, s65
    s_add_u32 s67, s66, 5120
    buffer_load_dwordx4 v[48:51], v7, s[36:39], s66 offen offset:0 sc1
    s_waitcnt vmcnt(5) lgkmcnt(15)
    s_setprio 1
    v_mfma_f32_16x16x32_bf16 v[228:231], v[212:215], v[28:31], v[228:231]
    v_mfma_f32_16x16x32_bf16 v[232:235], v[216:219], v[28:31], v[232:235]
    v_mfma_f32_16x16x32_bf16 v[236:239], v[220:223], v[28:31], v[236:239]
    v_mfma_f32_16x16x32_bf16 v[240:243], v[224:227], v[28:31], v[240:243]
    buffer_load_dwordx4 v[20:23], v7, s[36:39], s66 offen offset:2048 sc1
    s_waitcnt vmcnt(5) lgkmcnt(15)
    v_mfma_f32_16x16x32_bf16 v[228:231], v[52:55], v[32:35], v[228:231]
    v_mfma_f32_16x16x32_bf16 v[232:235], v[56:59], v[32:35], v[232:235]
    v_mfma_f32_16x16x32_bf16 v[236:239], v[60:63], v[32:35], v[236:239]
    v_mfma_f32_16x16x32_bf16 v[240:243], v[64:67], v[32:35], v[240:243]
    buffer_load_dwordx4 v[24:27], v7, s[36:39], s67 offen offset:0 sc1
    s_waitcnt vmcnt(5) lgkmcnt(15)
    v_mfma_f32_16x16x32_bf16 v[228:231], v[68:71], v[36:39], v[228:231]
    v_mfma_f32_16x16x32_bf16 v[232:235], v[72:75], v[36:39], v[232:235]
    v_mfma_f32_16x16x32_bf16 v[236:239], v[76:79], v[36:39], v[236:239]
    v_mfma_f32_16x16x32_bf16 v[240:243], v[80:83], v[36:39], v[240:243]
    buffer_load_dwordx4 v[28:31], v7, s[36:39], s67 offen offset:2048 sc1
    s_waitcnt vmcnt(5) lgkmcnt(15)
    v_mfma_f32_16x16x32_bf16 v[228:231], v[84:87], v[40:43], v[228:231]
    v_mfma_f32_16x16x32_bf16 v[232:235], v[88:91], v[40:43], v[232:235]
    v_mfma_f32_16x16x32_bf16 v[236:239], v[92:95], v[40:43], v[236:239]
    v_mfma_f32_16x16x32_bf16 v[240:243], v[96:99], v[40:43], v[240:243]
    buffer_load_dwordx4 v[32:35], v8, s[36:39], s66 offen sc1
    s_waitcnt vmcnt(5) lgkmcnt(15)
    v_mfma_f32_16x16x32_bf16 v[228:231], v[100:103], v[44:47], v[228:231]
    v_mfma_f32_16x16x32_bf16 v[232:235], v[104:107], v[44:47], v[232:235]
    v_mfma_f32_16x16x32_bf16 v[236:239], v[108:111], v[44:47], v[236:239]
    v_mfma_f32_16x16x32_bf16 v[240:243], v[112:115], v[44:47], v[240:243]
    s_waitcnt vmcnt(4) lgkmcnt(15)
    s_setprio 0
    v_mfma_f32_16x16x32_bf16 v[228:231], v[116:119], v[48:51], v[228:231]
    v_mfma_f32_16x16x32_bf16 v[232:235], v[120:123], v[48:51], v[232:235]
    v_mfma_f32_16x16x32_bf16 v[236:239], v[124:127], v[48:51], v[236:239]
    v_mfma_f32_16x16x32_bf16 v[240:243], v[128:131], v[48:51], v[240:243]
    s_waitcnt vmcnt(3) lgkmcnt(15)
    v_mfma_f32_16x16x32_bf16 v[228:231], v[132:135], v[20:23], v[228:231]
    v_mfma_f32_16x16x32_bf16 v[232:235], v[136:139], v[20:23], v[232:235]
    v_mfma_f32_16x16x32_bf16 v[236:239], v[140:143], v[20:23], v[236:239]
    v_mfma_f32_16x16x32_bf16 v[240:243], v[144:147], v[20:23], v[240:243]
    s_waitcnt vmcnt(2) lgkmcnt(15)
    v_mfma_f32_16x16x32_bf16 v[228:231], v[148:151], v[24:27], v[228:231]
    v_mfma_f32_16x16x32_bf16 v[232:235], v[152:155], v[24:27], v[232:235]
    v_mfma_f32_16x16x32_bf16 v[236:239], v[156:159], v[24:27], v[236:239]
    v_mfma_f32_16x16x32_bf16 v[240:243], v[160:163], v[24:27], v[240:243]
    s_waitcnt vmcnt(1) lgkmcnt(8)
    v_mfma_f32_16x16x32_bf16 v[228:231], v[164:167], v[28:31], v[228:231]
    v_mfma_f32_16x16x32_bf16 v[232:235], v[168:171], v[28:31], v[232:235]
    v_mfma_f32_16x16x32_bf16 v[236:239], v[172:175], v[28:31], v[236:239]
    v_mfma_f32_16x16x32_bf16 v[240:243], v[176:179], v[28:31], v[240:243]
    s_waitcnt vmcnt(0) lgkmcnt(0)
    v_mfma_f32_16x16x32_bf16 v[228:231], v[180:183], v[32:35], v[228:231]
    v_mfma_f32_16x16x32_bf16 v[232:235], v[184:187], v[32:35], v[232:235]
    v_mfma_f32_16x16x32_bf16 v[236:239], v[188:191], v[32:35], v[236:239]
    v_mfma_f32_16x16x32_bf16 v[240:243], v[192:195], v[32:35], v[240:243]
    s_nop 4
    v_cvt_pk_bf16_f32 v52, v228, v229
    v_cvt_pk_bf16_f32 v53, v230, v231
    v_cvt_pk_bf16_f32 v54, v232, v233
    v_cvt_pk_bf16_f32 v55, v234, v235
    v_cvt_pk_bf16_f32 v56, v236, v237
    v_cvt_pk_bf16_f32 v57, v238, v239
    v_cvt_pk_bf16_f32 v58, v240, v241
    v_cvt_pk_bf16_f32 v59, v242, v243
    s_nop 1
    v_permlane16_swap_b32 v52, v54
    v_permlane16_swap_b32 v53, v55
    v_permlane16_swap_b32 v56, v58
    v_permlane16_swap_b32 v57, v59
    v_mov_b32 v68, v52
    v_mov_b32 v69, v53
    v_mov_b32 v70, v54
    v_mov_b32 v71, v55
    v_mov_b32_dpp v52, v56 row_ror:8 row_mask:0xf bank_mask:0xc
    v_mov_b32_dpp v53, v57 row_ror:8 row_mask:0xf bank_mask:0xc
    v_mov_b32_dpp v54, v58 row_ror:8 row_mask:0xf bank_mask:0xc
    v_mov_b32_dpp v55, v59 row_ror:8 row_mask:0xf bank_mask:0xc
    v_mov_b32_dpp v56, v68 row_ror:8 row_mask:0xf bank_mask:0x3
    v_mov_b32_dpp v57, v69 row_ror:8 row_mask:0xf bank_mask:0x3
    v_mov_b32_dpp v58, v70 row_ror:8 row_mask:0xf bank_mask:0x3
    v_mov_b32_dpp v59, v71 row_ror:8 row_mask:0xf bank_mask:0x3
    buffer_store_dwordx4 v[52:55], v10, s[44:47], s63 offen sc1
    s_add_u32 s63, s63, 20480
    buffer_store_dwordx4 v[56:59], v10, s[44:47], s63 offen sc1
L_FIN:
L_END:
    s_endpgm
.section .rodata,"a"
.p2align 6
.amdhsa_kernel concat_heads__ssm_conv_h3__linear_attn_block__prompt_kernel
  .amdhsa_next_free_vgpr 256
  .amdhsa_next_free_sgpr 102
  .amdhsa_accum_offset 256
  .amdhsa_group_segment_fixed_size 0
  .amdhsa_kernarg_size 96
  .amdhsa_user_sgpr_count 2
  .amdhsa_user_sgpr_kernarg_segment_ptr 1
  .amdhsa_system_sgpr_workgroup_id_x 1
.end_amdhsa_kernel
```
